```python
import torch

def _softmax(x, axis=-1):
    return torch.softmax(x, dim=axis)
def _gelu(x):
    return torch.nn.functional.gelu(x, approximate="tanh")
def _silu(x):
    return torch.nn.functional.silu(x)
def _sigmoid(x):
    return torch.sigmoid(x)
def _layernorm(x, axis=-1, eps=1e-5):
    m = x.mean(dim=axis, keepdim=True)
    v = x.var(dim=axis, keepdim=True, unbiased=False)
    return (x - m) / torch.sqrt(v + eps)
def _scatter_add(tgt, idx, src, axis=0):
    return tgt.clone().index_add_(axis, idx, src)
def _segment_sum(src, seg, n):
    out = torch.zeros((n,) + src.shape[1:], dtype=src.dtype)
    return out.index_add_(0, seg, src)
def _pad(x, pw):
    flat = tuple(v for pair in reversed(pw) for v in pair)
    return torch.nn.functional.pad(x, flat)

kernel_name = 'gated_mix__softmax_full_mha__softmax_full_mha__prompt'

def setup_inputs():

    _w = (lambda a: (lambda t: t.to(torch.bfloat16) if t.is_floating_point() else t)(torch.as_tensor(a)))
    def _A_setup():
        B, S, D = 1, 2048, 512
        return {
            "x": _w((lambda *s: torch.randn(*s, dtype=torch.bfloat16) * 0.05)(B, S, D)),
            "wqkv": _w((lambda *s: torch.randn(*s, dtype=torch.bfloat16) * 0.8)(D, 3 * D)),
            "wo": _w((lambda *s: torch.randn(*s, dtype=torch.bfloat16) * 0.05)(D, D)),
        }
    _A_in = _A_setup()

    def _B_setup():
        B, S, D = 1, 2048, 512
        return {
            "x": _w((lambda *s: torch.randn(*s, dtype=torch.bfloat16) * 0.05)(B, S, D)),
            "wqkv": _w((lambda *s: torch.randn(*s, dtype=torch.bfloat16) * 0.8)(D, 3 * D)),
            "wo": _w((lambda *s: torch.randn(*s, dtype=torch.bfloat16) * 0.05)(D, D)),
        }
    _B_in = _B_setup()

    return {
        "A_x": _A_in["x"],
        "A_wqkv": _A_in["wqkv"],
        "A_wo": _A_in["wo"],
        "B_x": _B_in["x"],
        "B_wqkv": _B_in["wqkv"],
        "B_wo": _B_in["wo"],
        "gate_w": _w((lambda *s: torch.randn(*s, dtype=torch.bfloat16) * 0.05)(512) * 16.0),
    }

def reference(A_x, A_wqkv, A_wo, B_x, B_wqkv, B_wo, gate_w):
    def _A_ref(x, wqkv, wo):
        B, S, D = x.shape
        H = 32; Dh = D // H
        qkv = (lambda x, *d: x.permute(*d))((x @ wqkv).reshape(B, S, 3, H, Dh), 2, 0, 3, 1, 4)
        q, k, v = qkv[0], qkv[1], qkv[2]
        scale = Dh ** -0.5
        scores = torch.einsum("bhqd,bhkd->bhqk", q, k) * scale
        p = _softmax(scores, axis=-1)
        o = torch.einsum("bhqk,bhkd->bhqd", p, v)
        return (lambda x, *d: x.permute(*d))(o, 0, 2, 1, 3).reshape(B, S, D) @ wo

    def _B_ref(x, wqkv, wo):
        B, S, D = x.shape
        H = 32; Dh = D // H
        qkv = (lambda x, *d: x.permute(*d))((x @ wqkv).reshape(B, S, 3, H, Dh), 2, 0, 3, 1, 4)
        q, k, v = qkv[0], qkv[1], qkv[2]
        scale = Dh ** -0.5
        scores = torch.einsum("bhqd,bhkd->bhqk", q, k) * scale
        p = _softmax(scores, axis=-1)
        o = torch.einsum("bhqk,bhkd->bhqd", p, v)
        return (lambda x, *d: x.permute(*d))(o, 0, 2, 1, 3).reshape(B, S, D) @ wo

    x = A_x
    g = _sigmoid((x * gate_w).sum(-1, keepdims=True))
    a = _A_ref(x, A_wqkv, A_wo)
    b = _B_ref(x, B_wqkv, B_wo)
    return g * a + (1 - g) * b
```

```asm
; @launch grid=(256,1,1) block=(512,1,1) lds=163840
.amdgcn_target "amdgcn-amd-amdhsa--gfx950"
.text
.globl gated_mix__softmax_full_mha__softmax_full_mha__prompt_kernel
.p2align 8
.type gated_mix__softmax_full_mha__softmax_full_mha__prompt_kernel,@function
gated_mix__softmax_full_mha__softmax_full_mha__prompt_kernel:
    s_cmp_ge_u32 s2, 256
    s_cbranch_scc1 K_END
    s_load_dwordx2 s[20:21], s[0:1], 0
    s_load_dwordx2 s[24:25], s[0:1], 8
    s_load_dwordx2 s[14:15], s[0:1], 32
    s_load_dwordx2 s[10:11], s[0:1], 48
    s_load_dwordx2 s[12:13], s[0:1], 64
    s_load_dwordx2 s[28:29], s[0:1], 72
    v_lshrrev_b32 v1, 6, v0
    v_and_b32 v0, 63, v0
    v_readfirstlane_b32 s16, v1
    s_and_b32 s17, s2, 1
    s_lshr_b32 s3, s2, 3
    s_lshl_b32 s17, s17, 2
    s_and_b32 s18, s3, 3
    s_add_u32 s17, s17, s18
    s_lshl_b32 s9, s18, 1
    s_lshr_b32 s3, s3, 2
    s_add_u32 s9, s9, s3
    s_and_b32 s9, s9, 6
    s_bfe_u32 s19, s2, 0x20001
    s_lshl_b32 s18, s19, 3
    s_add_u32 s18, s18, s3
    s_mov_b32 s22, 0x200000
    s_mov_b32 s23, 0x00020000
    s_mov_b32 s26, 0x180000
    s_mov_b32 s27, s23
    v_lshrrev_b32 v1, 3, v0
    v_and_b32 v2, 7, v0
    v_lshrrev_b32 v3, 4, v0
    s_and_b32 s4, s16, 1
    s_lshl_b32 s4, s4, 2
    v_add_u32 v4, s4, v3
    v_xor_b32 v4, v4, v2
    v_lshlrev_b32 v4, 4, v4
    v_lshl_add_u32 v4, v1, 10, v4
    v_lshrrev_b32 v1, 2, v0
    v_mul_u32_u24 v5, 3072, v1
    v_and_b32 v2, 3, v0
    v_lshl_add_u32 v5, v2, 4, v5
    s_and_b32 s6, s16, 3
    s_lshl_b32 s4, s17, 18
    s_lshl_b32 s5, s6, 13
    s_add_u32 s4, s4, s5
    s_mul_i32 s5, s6, 49152
    s_and_b32 s7, s18, 15
    s_lshl_b32 s7, s7, 6
    s_add_u32 s5, s5, s7
    s_lshl_b32 s6, s6, 10
    s_cmp_ge_u32 s16, 4
    s_cbranch_scc1 HELPER
    s_lshl_b32 s35, s16, 8
    s_add_u32 s35, s35, 157696
    v_lshlrev_b32 v13, 2, v0
    v_add_u32 v13, s35, v13
    v_mov_b32 v14, 0
    ds_write_b32 v13, v14
    s_mov_b32 s8, s9
    s_mul_i32 s100, s8, 196608
    s_add_u32 s100, s100, s5
    s_lshl_b32 s8, s8, 7
    s_add_u32 s8, s8, s4
    s_cmp_ge_u32 s18, 16
    s_waitcnt lgkmcnt(0)
    s_cselect_b32 s24, s14, s24
    s_cselect_b32 s25, s15, s25
    s_add_u32 m0, s6, 36864
    s_add_u32 s7, s100, 1024
    buffer_load_dwordx4 v5, s[24:27], s7 offen lds
    s_add_u32 m0, s6, 0
    s_add_u32 s7, s8, 0
    buffer_load_dwordx4 v4, s[20:23], s7 offen lds
    s_add_u32 m0, s6, 40960
    s_add_u32 s7, s100, 2048
    buffer_load_dwordx4 v5, s[24:27], s7 offen lds
    s_add_u32 m0, s6, 4096
    s_add_u32 s7, s8, 32768
    buffer_load_dwordx4 v4, s[20:23], s7 offen lds
    s_add_u32 m0, s6, 32768
    s_add_u32 s7, s100, 0
    buffer_load_dwordx4 v5, s[24:27], s7 offen lds
    s_add_u32 m0, s6, 8192
    s_add_u32 s7, s8, 65536
    buffer_load_dwordx4 v4, s[20:23], s7 offen lds
    s_add_u32 m0, s6, 12288
    s_add_u32 s7, s8, 98304
    buffer_load_dwordx4 v4, s[20:23], s7 offen lds
    s_add_u32 m0, s6, 16384
    s_add_u32 s7, s8, 131072
    buffer_load_dwordx4 v4, s[20:23], s7 offen lds
    s_add_u32 m0, s6, 20480
    s_add_u32 s7, s8, 163840
    buffer_load_dwordx4 v4, s[20:23], s7 offen lds
    s_add_u32 m0, s6, 24576
    s_add_u32 s7, s8, 196608
    buffer_load_dwordx4 v4, s[20:23], s7 offen lds
    s_add_u32 m0, s6, 28672
    s_add_u32 s7, s8, 229376
    buffer_load_dwordx4 v4, s[20:23], s7 offen lds
    s_barrier
    s_mov_b32 s30, 0xd00000
    s_mov_b32 s31, s23
    s_mov_b32 s101, 0x100000
    s_and_b32 s33, s16, 1
    v_and_b32 v5, 31, v0
    v_lshrrev_b32 v6, 5, v0
    v_bfe_u32 v7, v0, 1, 3
    v_lshlrev_b32 v9, 7, v5
    s_lshl_b32 s34, s16, 13
    v_add_u32 v9, s34, v9
    v_add_u32 v10, 0, v6
    v_xor_b32 v10, v10, v7
    v_lshl_add_u32 v248, v10, 4, v9
    v_add_u32 v252, 90112, v248
    v_add_u32 v10, 2, v6
    v_xor_b32 v10, v10, v7
    v_lshl_add_u32 v249, v10, 4, v9
    v_add_u32 v253, 90112, v249
    v_add_u32 v10, 4, v6
    v_xor_b32 v10, v10, v7
    v_lshl_add_u32 v250, v10, 4, v9
    v_add_u32 v254, 90112, v250
    v_add_u32 v10, 6, v6
    v_xor_b32 v10, v10, v7
    v_lshl_add_u32 v251, v10, 4, v9
    v_add_u32 v255, 90112, v251
    v_bfe_u32 v9, v0, 2, 2
    v_lshl_add_u32 v9, v6, 3, v9
    v_lshlrev_b32 v9, 6, v9
    v_and_b32 v10, 3, v0
    v_lshl_add_u32 v9, v10, 3, v9
    v_bfe_u32 v10, v0, 4, 1
    v_lshl_add_u32 v1, v10, 5, v9
    v_add_u32 v1, 0x8000, v1
    v_add_u32 v2, 90112, v1
    s_lshl_b32 s35, s33, 5
    v_xor_b32 v3, s35, v1
    v_add_u32 v4, 90112, v3
    v_and_b32 v11, 3, v0
    v_lshlrev_b32 v11, 8, v11
    v_add_u32 v11, 156672, v11
    v_mov_b32 v8, 0xdddddddd
    v_and_b32 v9, 27, v5
    v_mov_b32 v10, 0x3f803f80
    v_cmp_eq_u32 vcc, 16, v9
    s_mov_b32 s36, 0x0000ffff
    s_mov_b32 s37, 0x0000ffff
    v_cndmask_b32 v12, 0, v10, vcc
    v_mov_b32 v14, 1
    v_lshlrev_b32 v15, 4, v0
    v_and_b32 v9, 0x33, v0
    v_bfe_u32 v10, v0, 2, 1
    v_lshl_or_b32 v9, v10, 3, v9
    v_bfe_u32 v10, v0, 3, 1
    v_lshl_or_b32 v9, v10, 2, v9
    v_lshlrev_b32 v9, 4, v9
    s_lshl_b32 s35, s33, 11
    v_add_u32 v10, s35, v9
    v_mov_b32 v9, v10
    v_mov_b32 v168, v12
    v_mov_b32 v169, v12
    v_mov_b32 v170, v12
    v_mov_b32 v171, v12
    v_mov_b32 v172, v12
    v_mov_b32 v173, v12
    v_mov_b32 v174, v12
    v_mov_b32 v175, v12
    v_mov_b32 v176, v12
    v_mov_b32 v177, v12
    v_mov_b32 v178, v12
    v_mov_b32 v179, v12
    v_mov_b32 v180, v12
    v_mov_b32 v181, v12
    v_mov_b32 v182, v12
    v_mov_b32 v183, v12
    v_mov_b32 v80, 0
    v_mov_b32 v81, 0
    v_mov_b32 v82, 0
    v_mov_b32 v83, 0
    v_mov_b32 v84, 0
    v_mov_b32 v85, 0
    v_mov_b32 v86, 0
    v_mov_b32 v87, 0
    v_mov_b32 v88, 0
    v_mov_b32 v89, 0
    v_mov_b32 v90, 0
    v_mov_b32 v91, 0
    v_mov_b32 v92, 0
    v_mov_b32 v93, 0
    v_mov_b32 v94, 0
    v_mov_b32 v95, 0
    v_mov_b32 v96, 0
    v_mov_b32 v97, 0
    v_mov_b32 v98, 0
    v_mov_b32 v99, 0
    v_mov_b32 v100, 0
    v_mov_b32 v101, 0
    v_mov_b32 v102, 0
    v_mov_b32 v103, 0
    v_mov_b32 v104, 0
    v_mov_b32 v105, 0
    v_mov_b32 v106, 0
    v_mov_b32 v107, 0
    v_mov_b32 v108, 0
    v_mov_b32 v109, 0
    v_mov_b32 v110, 0
    v_mov_b32 v111, 0
    v_mov_b32 v112, 0
    v_mov_b32 v113, 0
    v_mov_b32 v114, 0
    v_mov_b32 v115, 0
    v_mov_b32 v116, 0
    v_mov_b32 v117, 0
    v_mov_b32 v118, 0
    v_mov_b32 v119, 0
    v_mov_b32 v120, 0
    v_mov_b32 v121, 0
    v_mov_b32 v122, 0
    v_mov_b32 v123, 0
    v_mov_b32 v124, 0
    v_mov_b32 v125, 0
    v_mov_b32 v126, 0
    v_mov_b32 v127, 0
    v_mov_b32 v128, 0
    v_mov_b32 v129, 0
    v_mov_b32 v130, 0
    v_mov_b32 v131, 0
    v_mov_b32 v132, 0
    v_mov_b32 v133, 0
    v_mov_b32 v134, 0
    v_mov_b32 v135, 0
    v_mov_b32 v136, 0
    v_mov_b32 v137, 0
    v_mov_b32 v138, 0
    v_mov_b32 v139, 0
    v_mov_b32 v140, 0
    v_mov_b32 v141, 0
    v_mov_b32 v142, 0
    v_mov_b32 v143, 0
    v_mov_b32 v72, 0
    v_mov_b32 v73, 0
    v_mov_b32 v74, 0
    v_mov_b32 v75, 0
    v_mov_b32 v76, 0
    v_mov_b32 v77, 0
    v_mov_b32 v78, 0
    v_mov_b32 v79, 0
    v_and_b32 v7, 15, v0
    v_lshlrev_b32 v7, 4, v7
    v_lshl_add_u32 v7, v6, 9, v7
    v_bfe_u32 v6, v0, 4, 1
    v_lshl_add_u32 v6, v6, 11, v7
    s_mul_i32 s34, s16, 8224
    v_add_u32 v6, s34, v6
    v_add_u32 v5, s34, v15
    s_lshl_b32 s35, s16, 11
    s_add_u32 s35, s35, 135168
    v_add_u32 v7, s35, v15
    s_lshl_b32 s42, s18, 18
    s_lshl_b32 s43, s17, 15
    s_add_u32 s42, s42, s43
    s_add_u32 s43, s42, 4096
    s_lshl_b32 s44, s18, 12
    s_lshl_b32 s45, s16, 7
    s_add_u32 s44, s44, s45
    s_add_u32 s44, s44, 0xc00000
    s_waitcnt vmcnt(0)
    ds_add_u32 v13, v14
C_LAND:
    s_sub_u32 s101, s101, 1
    s_cbranch_scc1 K_END
    ds_read_b32 v12, v11 offset:1024
    s_waitcnt lgkmcnt(0)
    v_cmp_eq_u32 vcc, 0, v12
    s_cbranch_vccnz C_LAND
    ds_read_b128 v[32:35], v248 offset:0
    ds_read_b64_tr_b16 v[44:45], v1 offset:4096
    ds_read_b64_tr_b16 v[46:47], v1 offset:4352
    ds_read_b128 v[36:39], v248 offset:4096
    ds_read_b64_tr_b16 v[48:49], v1 offset:8192
    ds_read_b64_tr_b16 v[50:51], v1 offset:8448
    ds_read_b64_tr_b16 v[40:41], v3 offset:0
    ds_read_b64_tr_b16 v[42:43], v3 offset:256
    s_waitcnt lgkmcnt(0)
    v_mfma_f32_32x32x16_bf16 v[184:199], v[44:47], v[32:35], 0
    ds_read_b128 v[52:55], v249 offset:0
    ds_read_b64_tr_b16 v[64:65], v1 offset:5120
    ds_read_b64_tr_b16 v[66:67], v1 offset:5376
    v_mfma_f32_32x32x16_bf16 v[200:215], v[44:47], v[36:39], 0
    ds_read_b128 v[56:59], v249 offset:4096
    ds_read_b64_tr_b16 v[68:69], v1 offset:9216
    ds_read_b64_tr_b16 v[70:71], v1 offset:9472
    v_mfma_f32_32x32x16_bf16 v[216:231], v[32:35], v[48:51], 0
    ds_read_b64_tr_b16 v[60:61], v3 offset:1024
    ds_read_b64_tr_b16 v[62:63], v3 offset:1280
    v_mfma_f32_32x32x16_bf16 v[232:247], v[36:39], v[48:51], 0
    v_mfma_f32_32x32x16_bf16 v[144:159], v[40:43], v[32:35], 0
    v_mfma_f32_32x32x16_bf16 v[16:31], v[40:43], v[36:39], 0
    s_waitcnt lgkmcnt(0)
    v_mfma_f32_32x32x16_bf16 v[184:199], v[64:67], v[52:55], v[184:199]
    ds_read_b128 v[32:35], v250 offset:0
    ds_read_b64_tr_b16 v[44:45], v1 offset:6144
    ds_read_b64_tr_b16 v[46:47], v1 offset:6400
    v_mfma_f32_32x32x16_bf16 v[200:215], v[64:67], v[56:59], v[200:215]
    ds_read_b128 v[36:39], v250 offset:4096
    ds_read_b64_tr_b16 v[48:49], v1 offset:10240
    ds_read_b64_tr_b16 v[50:51], v1 offset:10496
    v_mfma_f32_32x32x16_bf16 v[216:231], v[52:55], v[68:71], v[216:231]
    ds_read_b64_tr_b16 v[40:41], v3 offset:2048
    ds_read_b64_tr_b16 v[42:43], v3 offset:2304
    v_mfma_f32_32x32x16_bf16 v[232:247], v[56:59], v[68:71], v[232:247]
    v_mfma_f32_32x32x16_bf16 v[144:159], v[60:63], v[52:55], v[144:159]
    v_mfma_f32_32x32x16_bf16 v[16:31], v[60:63], v[56:59], v[16:31]
    s_waitcnt lgkmcnt(0)
    v_mfma_f32_32x32x16_bf16 v[184:199], v[44:47], v[32:35], v[184:199]
    ds_read_b128 v[52:55], v251 offset:0
    ds_read_b64_tr_b16 v[64:65], v1 offset:7168
    ds_read_b64_tr_b16 v[66:67], v1 offset:7424
    v_mfma_f32_32x32x16_bf16 v[200:215], v[44:47], v[36:39], v[200:215]
    ds_read_b128 v[56:59], v251 offset:4096
    ds_read_b64_tr_b16 v[68:69], v1 offset:11264
    ds_read_b64_tr_b16 v[70:71], v1 offset:11520
    v_mfma_f32_32x32x16_bf16 v[216:231], v[32:35], v[48:51], v[216:231]
    ds_read_b64_tr_b16 v[60:61], v3 offset:3072
    ds_read_b64_tr_b16 v[62:63], v3 offset:3328
    v_mfma_f32_32x32x16_bf16 v[232:247], v[36:39], v[48:51], v[232:247]
    v_mfma_f32_32x32x16_bf16 v[144:159], v[40:43], v[32:35], v[144:159]
    v_mfma_f32_32x32x16_bf16 v[16:31], v[40:43], v[36:39], v[16:31]
    s_waitcnt lgkmcnt(0)
    v_mfma_f32_32x32x16_bf16 v[184:199], v[64:67], v[52:55], v[184:199]
    s_barrier
    ds_read_b128 v[32:35], v248 offset:45056
    ds_read_b64_tr_b16 v[44:45], v1 offset:49152
    ds_read_b64_tr_b16 v[46:47], v1 offset:49408
    v_mfma_f32_32x32x16_bf16 v[200:215], v[64:67], v[56:59], v[200:215]
    ds_read_b128 v[36:39], v248 offset:49152
    ds_read_b64_tr_b16 v[48:49], v1 offset:53248
    ds_read_b64_tr_b16 v[50:51], v1 offset:53504
    v_mfma_f32_32x32x16_bf16 v[216:231], v[52:55], v[68:71], v[216:231]
    ds_read_b64_tr_b16 v[40:41], v3 offset:45056
    ds_read_b64_tr_b16 v[42:43], v3 offset:45312
    v_mfma_f32_32x32x16_bf16 v[232:247], v[56:59], v[68:71], v[232:247]
    v_mfma_f32_32x32x16_bf16 v[144:159], v[60:63], v[52:55], v[144:159]
    v_mfma_f32_32x32x16_bf16 v[16:31], v[60:63], v[56:59], v[16:31]
    s_waitcnt lgkmcnt(0)
    v_mfma_f32_32x32x16_bf16 v[184:199], v[44:47], v[32:35], v[184:199]
    ds_read_b128 v[52:55], v249 offset:45056
    ds_read_b64_tr_b16 v[64:65], v1 offset:50176
    ds_read_b64_tr_b16 v[66:67], v1 offset:50432
    v_mfma_f32_32x32x16_bf16 v[200:215], v[44:47], v[36:39], v[200:215]
    ds_read_b128 v[56:59], v249 offset:49152
    ds_read_b64_tr_b16 v[68:69], v1 offset:54272
    ds_read_b64_tr_b16 v[70:71], v1 offset:54528
    v_mfma_f32_32x32x16_bf16 v[216:231], v[32:35], v[48:51], v[216:231]
    ds_read_b64_tr_b16 v[60:61], v3 offset:46080
    ds_read_b64_tr_b16 v[62:63], v3 offset:46336
    v_mfma_f32_32x32x16_bf16 v[232:247], v[36:39], v[48:51], v[232:247]
    v_mfma_f32_32x32x16_bf16 v[144:159], v[40:43], v[32:35], v[144:159]
    v_mfma_f32_32x32x16_bf16 v[16:31], v[40:43], v[36:39], v[16:31]
    s_waitcnt lgkmcnt(0)
    v_mfma_f32_32x32x16_bf16 v[184:199], v[64:67], v[52:55], v[184:199]
    ds_read_b128 v[32:35], v250 offset:45056
    ds_read_b64_tr_b16 v[44:45], v1 offset:51200
    ds_read_b64_tr_b16 v[46:47], v1 offset:51456
    v_mfma_f32_32x32x16_bf16 v[200:215], v[64:67], v[56:59], v[200:215]
    ds_read_b128 v[36:39], v250 offset:49152
    ds_read_b64_tr_b16 v[48:49], v1 offset:55296
    ds_read_b64_tr_b16 v[50:51], v1 offset:55552
    v_mfma_f32_32x32x16_bf16 v[216:231], v[52:55], v[68:71], v[216:231]
    ds_read_b64_tr_b16 v[40:41], v3 offset:47104
    ds_read_b64_tr_b16 v[42:43], v3 offset:47360
    v_mfma_f32_32x32x16_bf16 v[232:247], v[56:59], v[68:71], v[232:247]
    v_mfma_f32_32x32x16_bf16 v[144:159], v[60:63], v[52:55], v[144:159]
    v_mfma_f32_32x32x16_bf16 v[16:31], v[60:63], v[56:59], v[16:31]
    s_waitcnt lgkmcnt(0)
    v_mfma_f32_32x32x16_bf16 v[184:199], v[44:47], v[32:35], v[184:199]
    ds_read_b128 v[52:55], v251 offset:45056
    ds_read_b64_tr_b16 v[64:65], v1 offset:52224
    ds_read_b64_tr_b16 v[66:67], v1 offset:52480
    v_mfma_f32_32x32x16_bf16 v[200:215], v[44:47], v[36:39], v[200:215]
    ds_read_b128 v[56:59], v251 offset:49152
    ds_read_b64_tr_b16 v[68:69], v1 offset:56320
    ds_read_b64_tr_b16 v[70:71], v1 offset:56576
    v_mfma_f32_32x32x16_bf16 v[216:231], v[32:35], v[48:51], v[216:231]
    ds_read_b64_tr_b16 v[60:61], v3 offset:48128
    ds_read_b64_tr_b16 v[62:63], v3 offset:48384
    v_mfma_f32_32x32x16_bf16 v[232:247], v[36:39], v[48:51], v[232:247]
    v_mfma_f32_32x32x16_bf16 v[144:159], v[40:43], v[32:35], v[144:159]
    v_mfma_f32_32x32x16_bf16 v[16:31], v[40:43], v[36:39], v[16:31]
    s_waitcnt lgkmcnt(0)
    v_mfma_f32_32x32x16_bf16 v[184:199], v[64:67], v[52:55], v[184:199]
    s_barrier
    ds_read_b128 v[32:35], v252 offset:0
    ds_read_b64_tr_b16 v[44:45], v2 offset:4096
    ds_read_b64_tr_b16 v[46:47], v2 offset:4352
    v_mfma_f32_32x32x16_bf16 v[200:215], v[64:67], v[56:59], v[200:215]
    ds_read_b128 v[36:39], v252 offset:4096
    ds_read_b64_tr_b16 v[48:49], v2 offset:8192
    ds_read_b64_tr_b16 v[50:51], v2 offset:8448
    v_mfma_f32_32x32x16_bf16 v[216:231], v[52:55], v[68:71], v[216:231]
    ds_read_b64_tr_b16 v[40:41], v4 offset:0
    ds_read_b64_tr_b16 v[42:43], v4 offset:256
    v_mfma_f32_32x32x16_bf16 v[232:247], v[56:59], v[68:71], v[232:247]
    v_mfma_f32_32x32x16_bf16 v[144:159], v[60:63], v[52:55], v[144:159]
    v_mfma_f32_32x32x16_bf16 v[16:31], v[60:63], v[56:59], v[16:31]
    s_waitcnt lgkmcnt(0)
    v_mfma_f32_32x32x16_bf16 v[184:199], v[44:47], v[32:35], v[184:199]
    ds_read_b128 v[52:55], v253 offset:0
    ds_read_b64_tr_b16 v[64:65], v2 offset:5120
    ds_read_b64_tr_b16 v[66:67], v2 offset:5376
    v_mfma_f32_32x32x16_bf16 v[200:215], v[44:47], v[36:39], v[200:215]
    ds_read_b128 v[56:59], v253 offset:4096
    ds_read_b64_tr_b16 v[68:69], v2 offset:9216
    ds_read_b64_tr_b16 v[70:71], v2 offset:9472
    v_mfma_f32_32x32x16_bf16 v[216:231], v[32:35], v[48:51], v[216:231]
    ds_read_b64_tr_b16 v[60:61], v4 offset:1024
    ds_read_b64_tr_b16 v[62:63], v4 offset:1280
    v_mfma_f32_32x32x16_bf16 v[232:247], v[36:39], v[48:51], v[232:247]
    v_mfma_f32_32x32x16_bf16 v[144:159], v[40:43], v[32:35], v[144:159]
    v_mfma_f32_32x32x16_bf16 v[16:31], v[40:43], v[36:39], v[16:31]
    s_waitcnt lgkmcnt(0)
    v_mfma_f32_32x32x16_bf16 v[184:199], v[64:67], v[52:55], v[184:199]
    ds_read_b128 v[32:35], v254 offset:0
    ds_read_b64_tr_b16 v[44:45], v2 offset:6144
    ds_read_b64_tr_b16 v[46:47], v2 offset:6400
    v_mfma_f32_32x32x16_bf16 v[200:215], v[64:67], v[56:59], v[200:215]
    ds_read_b128 v[36:39], v254 offset:4096
    ds_read_b64_tr_b16 v[48:49], v2 offset:10240
    ds_read_b64_tr_b16 v[50:51], v2 offset:10496
    v_mfma_f32_32x32x16_bf16 v[216:231], v[52:55], v[68:71], v[216:231]
    ds_read_b64_tr_b16 v[40:41], v4 offset:2048
    ds_read_b64_tr_b16 v[42:43], v4 offset:2304
    v_mfma_f32_32x32x16_bf16 v[232:247], v[56:59], v[68:71], v[232:247]
    v_mfma_f32_32x32x16_bf16 v[144:159], v[60:63], v[52:55], v[144:159]
    v_mfma_f32_32x32x16_bf16 v[16:31], v[60:63], v[56:59], v[16:31]
    s_waitcnt lgkmcnt(0)
    v_mfma_f32_32x32x16_bf16 v[184:199], v[44:47], v[32:35], v[184:199]
    ds_read_b128 v[52:55], v255 offset:0
    ds_read_b64_tr_b16 v[64:65], v2 offset:7168
    ds_read_b64_tr_b16 v[66:67], v2 offset:7424
    v_mfma_f32_32x32x16_bf16 v[200:215], v[44:47], v[36:39], v[200:215]
    ds_read_b128 v[56:59], v255 offset:4096
    ds_read_b64_tr_b16 v[68:69], v2 offset:11264
    ds_read_b64_tr_b16 v[70:71], v2 offset:11520
    v_mfma_f32_32x32x16_bf16 v[216:231], v[32:35], v[48:51], v[216:231]
    ds_read_b64_tr_b16 v[60:61], v4 offset:3072
    ds_read_b64_tr_b16 v[62:63], v4 offset:3328
    v_mfma_f32_32x32x16_bf16 v[232:247], v[36:39], v[48:51], v[232:247]
    v_mfma_f32_32x32x16_bf16 v[144:159], v[40:43], v[32:35], v[144:159]
    v_mfma_f32_32x32x16_bf16 v[16:31], v[40:43], v[36:39], v[16:31]
    s_waitcnt lgkmcnt(0)
    v_mfma_f32_32x32x16_bf16 v[184:199], v[64:67], v[52:55], v[184:199]
    s_barrier
    ds_read_b128 v[32:35], v248 offset:0
    ds_read_b64_tr_b16 v[44:45], v1 offset:4096
    ds_read_b64_tr_b16 v[46:47], v1 offset:4352
    v_mfma_f32_32x32x16_bf16 v[200:215], v[64:67], v[56:59], v[200:215]
    ds_read_b128 v[36:39], v248 offset:4096
    ds_read_b64_tr_b16 v[48:49], v1 offset:8192
    ds_read_b64_tr_b16 v[50:51], v1 offset:8448
    v_mfma_f32_32x32x16_bf16 v[216:231], v[52:55], v[68:71], v[216:231]
    ds_read_b64_tr_b16 v[40:41], v3 offset:0
    ds_read_b64_tr_b16 v[42:43], v3 offset:256
    v_mfma_f32_32x32x16_bf16 v[232:247], v[56:59], v[68:71], v[232:247]
    v_mfma_f32_32x32x16_bf16 v[144:159], v[60:63], v[52:55], v[144:159]
    v_mfma_f32_32x32x16_bf16 v[16:31], v[60:63], v[56:59], v[16:31]
    s_waitcnt lgkmcnt(0)
    v_mfma_f32_32x32x16_bf16 v[184:199], v[44:47], v[32:35], v[184:199]
    ds_read_b128 v[52:55], v249 offset:0
    ds_read_b64_tr_b16 v[64:65], v1 offset:5120
    ds_read_b64_tr_b16 v[66:67], v1 offset:5376
    v_mfma_f32_32x32x16_bf16 v[200:215], v[44:47], v[36:39], v[200:215]
    ds_read_b128 v[56:59], v249 offset:4096
    ds_read_b64_tr_b16 v[68:69], v1 offset:9216
    ds_read_b64_tr_b16 v[70:71], v1 offset:9472
    v_mfma_f32_32x32x16_bf16 v[216:231], v[32:35], v[48:51], v[216:231]
    ds_read_b64_tr_b16 v[60:61], v3 offset:1024
    ds_read_b64_tr_b16 v[62:63], v3 offset:1280
    v_mfma_f32_32x32x16_bf16 v[232:247], v[36:39], v[48:51], v[232:247]
    v_mfma_f32_32x32x16_bf16 v[144:159], v[40:43], v[32:35], v[144:159]
    v_mfma_f32_32x32x16_bf16 v[16:31], v[40:43], v[36:39], v[16:31]
    s_waitcnt lgkmcnt(0)
    v_mfma_f32_32x32x16_bf16 v[184:199], v[64:67], v[52:55], v[184:199]
    ds_read_b128 v[32:35], v250 offset:0
    ds_read_b64_tr_b16 v[44:45], v1 offset:6144
    ds_read_b64_tr_b16 v[46:47], v1 offset:6400
    v_mfma_f32_32x32x16_bf16 v[200:215], v[64:67], v[56:59], v[200:215]
    ds_read_b128 v[36:39], v250 offset:4096
    ds_read_b64_tr_b16 v[48:49], v1 offset:10240
    ds_read_b64_tr_b16 v[50:51], v1 offset:10496
    v_mfma_f32_32x32x16_bf16 v[216:231], v[52:55], v[68:71], v[216:231]
    ds_read_b64_tr_b16 v[40:41], v3 offset:2048
    ds_read_b64_tr_b16 v[42:43], v3 offset:2304
    v_mfma_f32_32x32x16_bf16 v[232:247], v[56:59], v[68:71], v[232:247]
    v_mfma_f32_32x32x16_bf16 v[144:159], v[60:63], v[52:55], v[144:159]
    v_mfma_f32_32x32x16_bf16 v[16:31], v[60:63], v[56:59], v[16:31]
    s_waitcnt lgkmcnt(0)
    v_mfma_f32_32x32x16_bf16 v[184:199], v[44:47], v[32:35], v[184:199]
    ds_read_b128 v[52:55], v251 offset:0
    ds_read_b64_tr_b16 v[64:65], v1 offset:7168
    ds_read_b64_tr_b16 v[66:67], v1 offset:7424
    v_mfma_f32_32x32x16_bf16 v[200:215], v[44:47], v[36:39], v[200:215]
    ds_read_b128 v[56:59], v251 offset:4096
    ds_read_b64_tr_b16 v[68:69], v1 offset:11264
    ds_read_b64_tr_b16 v[70:71], v1 offset:11520
    v_mfma_f32_32x32x16_bf16 v[216:231], v[32:35], v[48:51], v[216:231]
    ds_read_b64_tr_b16 v[60:61], v3 offset:3072
    ds_read_b64_tr_b16 v[62:63], v3 offset:3328
    v_mfma_f32_32x32x16_bf16 v[232:247], v[36:39], v[48:51], v[232:247]
    v_mfma_f32_32x32x16_bf16 v[144:159], v[40:43], v[32:35], v[144:159]
    v_mfma_f32_32x32x16_bf16 v[16:31], v[40:43], v[36:39], v[16:31]
    s_waitcnt lgkmcnt(0)
    v_mfma_f32_32x32x16_bf16 v[184:199], v[64:67], v[52:55], v[184:199]
    s_barrier
    ds_read_b128 v[32:35], v248 offset:45056
    ds_read_b64_tr_b16 v[44:45], v1 offset:49152
    ds_read_b64_tr_b16 v[46:47], v1 offset:49408
    v_mfma_f32_32x32x16_bf16 v[200:215], v[64:67], v[56:59], v[200:215]
    ds_read_b128 v[36:39], v248 offset:49152
    ds_read_b64_tr_b16 v[48:49], v1 offset:53248
    ds_read_b64_tr_b16 v[50:51], v1 offset:53504
    v_mfma_f32_32x32x16_bf16 v[216:231], v[52:55], v[68:71], v[216:231]
    ds_read_b64_tr_b16 v[40:41], v3 offset:45056
    ds_read_b64_tr_b16 v[42:43], v3 offset:45312
    v_mfma_f32_32x32x16_bf16 v[232:247], v[56:59], v[68:71], v[232:247]
    v_mfma_f32_32x32x16_bf16 v[144:159], v[60:63], v[52:55], v[144:159]
    v_mfma_f32_32x32x16_bf16 v[16:31], v[60:63], v[56:59], v[16:31]
    s_waitcnt lgkmcnt(0)
    v_mfma_f32_32x32x16_bf16 v[184:199], v[44:47], v[32:35], v[184:199]
    ds_read_b128 v[52:55], v249 offset:45056
    ds_read_b64_tr_b16 v[64:65], v1 offset:50176
    ds_read_b64_tr_b16 v[66:67], v1 offset:50432
    v_mfma_f32_32x32x16_bf16 v[200:215], v[44:47], v[36:39], v[200:215]
    ds_read_b128 v[56:59], v249 offset:49152
    ds_read_b64_tr_b16 v[68:69], v1 offset:54272
    ds_read_b64_tr_b16 v[70:71], v1 offset:54528
    v_mfma_f32_32x32x16_bf16 v[216:231], v[32:35], v[48:51], v[216:231]
    ds_read_b64_tr_b16 v[60:61], v3 offset:46080
    ds_read_b64_tr_b16 v[62:63], v3 offset:46336
    v_mfma_f32_32x32x16_bf16 v[232:247], v[36:39], v[48:51], v[232:247]
    v_mfma_f32_32x32x16_bf16 v[144:159], v[40:43], v[32:35], v[144:159]
    v_mfma_f32_32x32x16_bf16 v[16:31], v[40:43], v[36:39], v[16:31]
    s_waitcnt lgkmcnt(0)
    v_mfma_f32_32x32x16_bf16 v[184:199], v[64:67], v[52:55], v[184:199]
    ds_read_b128 v[32:35], v250 offset:45056
    ds_read_b64_tr_b16 v[44:45], v1 offset:51200
    ds_read_b64_tr_b16 v[46:47], v1 offset:51456
    v_mfma_f32_32x32x16_bf16 v[200:215], v[64:67], v[56:59], v[200:215]
    ds_read_b128 v[36:39], v250 offset:49152
    ds_read_b64_tr_b16 v[48:49], v1 offset:55296
    ds_read_b64_tr_b16 v[50:51], v1 offset:55552
    v_mfma_f32_32x32x16_bf16 v[216:231], v[52:55], v[68:71], v[216:231]
    ds_read_b64_tr_b16 v[40:41], v3 offset:47104
    ds_read_b64_tr_b16 v[42:43], v3 offset:47360
    v_mfma_f32_32x32x16_bf16 v[232:247], v[56:59], v[68:71], v[232:247]
    v_mfma_f32_32x32x16_bf16 v[144:159], v[60:63], v[52:55], v[144:159]
    v_mfma_f32_32x32x16_bf16 v[16:31], v[60:63], v[56:59], v[16:31]
    s_waitcnt lgkmcnt(0)
    v_mfma_f32_32x32x16_bf16 v[184:199], v[44:47], v[32:35], v[184:199]
    ds_read_b128 v[52:55], v251 offset:45056
    ds_read_b64_tr_b16 v[64:65], v1 offset:52224
    ds_read_b64_tr_b16 v[66:67], v1 offset:52480
    v_mfma_f32_32x32x16_bf16 v[200:215], v[44:47], v[36:39], v[200:215]
    ds_read_b128 v[56:59], v251 offset:49152
    ds_read_b64_tr_b16 v[68:69], v1 offset:56320
    ds_read_b64_tr_b16 v[70:71], v1 offset:56576
    v_mfma_f32_32x32x16_bf16 v[216:231], v[32:35], v[48:51], v[216:231]
    ds_read_b64_tr_b16 v[60:61], v3 offset:48128
    ds_read_b64_tr_b16 v[62:63], v3 offset:48384
    v_mfma_f32_32x32x16_bf16 v[232:247], v[36:39], v[48:51], v[232:247]
    v_mfma_f32_32x32x16_bf16 v[144:159], v[40:43], v[32:35], v[144:159]
    v_mfma_f32_32x32x16_bf16 v[16:31], v[40:43], v[36:39], v[16:31]
    s_waitcnt lgkmcnt(0)
    v_mfma_f32_32x32x16_bf16 v[184:199], v[64:67], v[52:55], v[184:199]
    s_barrier
    ds_read_b128 v[32:35], v252 offset:0
    ds_read_b64_tr_b16 v[44:45], v2 offset:4096
    ds_read_b64_tr_b16 v[46:47], v2 offset:4352
    v_mfma_f32_32x32x16_bf16 v[200:215], v[64:67], v[56:59], v[200:215]
    ds_read_b128 v[36:39], v252 offset:4096
    ds_read_b64_tr_b16 v[48:49], v2 offset:8192
    ds_read_b64_tr_b16 v[50:51], v2 offset:8448
    v_mfma_f32_32x32x16_bf16 v[216:231], v[52:55], v[68:71], v[216:231]
    ds_read_b64_tr_b16 v[40:41], v4 offset:0
    ds_read_b64_tr_b16 v[42:43], v4 offset:256
    v_mfma_f32_32x32x16_bf16 v[232:247], v[56:59], v[68:71], v[232:247]
    v_mfma_f32_32x32x16_bf16 v[144:159], v[60:63], v[52:55], v[144:159]
    v_mfma_f32_32x32x16_bf16 v[16:31], v[60:63], v[56:59], v[16:31]
    s_waitcnt lgkmcnt(0)
    v_mfma_f32_32x32x16_bf16 v[184:199], v[44:47], v[32:35], v[184:199]
    ds_read_b128 v[52:55], v253 offset:0
    ds_read_b64_tr_b16 v[64:65], v2 offset:5120
    ds_read_b64_tr_b16 v[66:67], v2 offset:5376
    v_mfma_f32_32x32x16_bf16 v[200:215], v[44:47], v[36:39], v[200:215]
    ds_read_b128 v[56:59], v253 offset:4096
    ds_read_b64_tr_b16 v[68:69], v2 offset:9216
    ds_read_b64_tr_b16 v[70:71], v2 offset:9472
    v_mfma_f32_32x32x16_bf16 v[216:231], v[32:35], v[48:51], v[216:231]
    ds_read_b64_tr_b16 v[60:61], v4 offset:1024
    ds_read_b64_tr_b16 v[62:63], v4 offset:1280
    v_mfma_f32_32x32x16_bf16 v[232:247], v[36:39], v[48:51], v[232:247]
    v_mfma_f32_32x32x16_bf16 v[144:159], v[40:43], v[32:35], v[144:159]
    v_mfma_f32_32x32x16_bf16 v[16:31], v[40:43], v[36:39], v[16:31]
    s_waitcnt lgkmcnt(0)
    v_mfma_f32_32x32x16_bf16 v[184:199], v[64:67], v[52:55], v[184:199]
    ds_read_b128 v[32:35], v254 offset:0
    ds_read_b64_tr_b16 v[44:45], v2 offset:6144
    ds_read_b64_tr_b16 v[46:47], v2 offset:6400
    v_mfma_f32_32x32x16_bf16 v[200:215], v[64:67], v[56:59], v[200:215]
    ds_read_b128 v[36:39], v254 offset:4096
    ds_read_b64_tr_b16 v[48:49], v2 offset:10240
    ds_read_b64_tr_b16 v[50:51], v2 offset:10496
    v_mfma_f32_32x32x16_bf16 v[216:231], v[52:55], v[68:71], v[216:231]
    ds_read_b64_tr_b16 v[40:41], v4 offset:2048
    ds_read_b64_tr_b16 v[42:43], v4 offset:2304
    v_mfma_f32_32x32x16_bf16 v[232:247], v[56:59], v[68:71], v[232:247]
    v_mfma_f32_32x32x16_bf16 v[144:159], v[60:63], v[52:55], v[144:159]
    v_mfma_f32_32x32x16_bf16 v[16:31], v[60:63], v[56:59], v[16:31]
    s_waitcnt lgkmcnt(0)
    v_mfma_f32_32x32x16_bf16 v[184:199], v[44:47], v[32:35], v[184:199]
    ds_read_b128 v[52:55], v255 offset:0
    ds_read_b64_tr_b16 v[64:65], v2 offset:7168
    ds_read_b64_tr_b16 v[66:67], v2 offset:7424
    v_mfma_f32_32x32x16_bf16 v[200:215], v[44:47], v[36:39], v[200:215]
    ds_read_b128 v[56:59], v255 offset:4096
    ds_read_b64_tr_b16 v[68:69], v2 offset:11264
    ds_read_b64_tr_b16 v[70:71], v2 offset:11520
    v_mfma_f32_32x32x16_bf16 v[216:231], v[32:35], v[48:51], v[216:231]
    ds_read_b64_tr_b16 v[60:61], v4 offset:3072
    ds_read_b64_tr_b16 v[62:63], v4 offset:3328
    v_mfma_f32_32x32x16_bf16 v[232:247], v[36:39], v[48:51], v[232:247]
    v_mfma_f32_32x32x16_bf16 v[144:159], v[40:43], v[32:35], v[144:159]
    v_mfma_f32_32x32x16_bf16 v[16:31], v[40:43], v[36:39], v[16:31]
    s_waitcnt lgkmcnt(0)
    v_mfma_f32_32x32x16_bf16 v[184:199], v[64:67], v[52:55], v[184:199]
    s_barrier
    ds_read_b128 v[32:35], v248 offset:0
    ds_read_b64_tr_b16 v[44:45], v1 offset:4096
    ds_read_b64_tr_b16 v[46:47], v1 offset:4352
    v_mfma_f32_32x32x16_bf16 v[200:215], v[64:67], v[56:59], v[200:215]
    ds_read_b128 v[36:39], v248 offset:4096
    ds_read_b64_tr_b16 v[48:49], v1 offset:8192
    ds_read_b64_tr_b16 v[50:51], v1 offset:8448
    v_mfma_f32_32x32x16_bf16 v[216:231], v[52:55], v[68:71], v[216:231]
    ds_read_b64_tr_b16 v[40:41], v3 offset:0
    ds_read_b64_tr_b16 v[42:43], v3 offset:256
    v_mfma_f32_32x32x16_bf16 v[232:247], v[56:59], v[68:71], v[232:247]
    v_mfma_f32_32x32x16_bf16 v[144:159], v[60:63], v[52:55], v[144:159]
    v_mfma_f32_32x32x16_bf16 v[16:31], v[60:63], v[56:59], v[16:31]
    s_waitcnt lgkmcnt(0)
    v_mfma_f32_32x32x16_bf16 v[184:199], v[44:47], v[32:35], v[184:199]
    ds_read_b128 v[52:55], v249 offset:0
    ds_read_b64_tr_b16 v[64:65], v1 offset:5120
    ds_read_b64_tr_b16 v[66:67], v1 offset:5376
    v_mfma_f32_32x32x16_bf16 v[200:215], v[44:47], v[36:39], v[200:215]
    ds_read_b128 v[56:59], v249 offset:4096
    ds_read_b64_tr_b16 v[68:69], v1 offset:9216
    ds_read_b64_tr_b16 v[70:71], v1 offset:9472
    v_mfma_f32_32x32x16_bf16 v[216:231], v[32:35], v[48:51], v[216:231]
    ds_read_b64_tr_b16 v[60:61], v3 offset:1024
    ds_read_b64_tr_b16 v[62:63], v3 offset:1280
    v_mfma_f32_32x32x16_bf16 v[232:247], v[36:39], v[48:51], v[232:247]
    s_mov_b32 vcc_lo, 0x110000
    s_mov_b32 vcc_hi, 0x110000
    v_mov_b32 v162, 0x30000
    v_mfma_f32_32x32x16_bf16 v[144:159], v[40:43], v[32:35], v[144:159]
    v_mov_b32 v160, 3072
    v_cndmask_b32 v252, v162, v10, s[36:37]
    v_cndmask_b32 v252, v252, v160, vcc
    v_mfma_f32_32x32x16_bf16 v[16:31], v[40:43], v[36:39], v[16:31]
    s_waitcnt lgkmcnt(0)
    v_mfma_f32_32x32x16_bf16 v[184:199], v[64:67], v[52:55], v[184:199]
    ds_read_b128 v[32:35], v250 offset:0
    ds_read_b64_tr_b16 v[44:45], v1 offset:6144
    ds_read_b64_tr_b16 v[46:47], v1 offset:6400
    v_mfma_f32_32x32x16_bf16 v[200:215], v[64:67], v[56:59], v[200:215]
    ds_read_b128 v[36:39], v250 offset:4096
    ds_read_b64_tr_b16 v[48:49], v1 offset:10240
    ds_read_b64_tr_b16 v[50:51], v1 offset:10496
    v_mfma_f32_32x32x16_bf16 v[216:231], v[52:55], v[68:71], v[216:231]
    ds_read_b64_tr_b16 v[40:41], v3 offset:2048
    ds_read_b64_tr_b16 v[42:43], v3 offset:2304
    v_mfma_f32_32x32x16_bf16 v[232:247], v[56:59], v[68:71], v[232:247]
    v_mov_b32 v160, 2816
    v_bfe_u32 v161, v0, 2, 1
    v_cndmask_b32 v253, v252, v160, vcc
    v_mfma_f32_32x32x16_bf16 v[144:159], v[60:63], v[52:55], v[144:159]
    v_mul_u32_u24 v161, 4112, v161
    v_mov_b32 v254, v252
    s_add_u32 s35, s34, 4096
    v_mfma_f32_32x32x16_bf16 v[16:31], v[60:63], v[56:59], v[16:31]
    s_waitcnt lgkmcnt(0)
    v_mfma_f32_32x32x16_bf16 v[184:199], v[44:47], v[32:35], v[184:199]
    ds_read_b128 v[52:55], v251 offset:0
    ds_read_b64_tr_b16 v[64:65], v1 offset:7168
    ds_read_b64_tr_b16 v[66:67], v1 offset:7424
    v_mfma_f32_32x32x16_bf16 v[200:215], v[44:47], v[36:39], v[200:215]
    ds_read_b128 v[56:59], v251 offset:4096
    ds_read_b64_tr_b16 v[68:69], v1 offset:11264
    ds_read_b64_tr_b16 v[70:71], v1 offset:11520
    v_mfma_f32_32x32x16_bf16 v[216:231], v[32:35], v[48:51], v[216:231]
    ds_read_b64_tr_b16 v[60:61], v3 offset:3072
    ds_read_b64_tr_b16 v[62:63], v3 offset:3328
    v_mfma_f32_32x32x16_bf16 v[232:247], v[36:39], v[48:51], v[232:247]
    v_add_u32 v161, s35, v161
    v_mov_b32 v255, v253
    v_cndmask_b32 v161, v162, v161, vcc
    v_mfma_f32_32x32x16_bf16 v[144:159], v[40:43], v[32:35], v[144:159]
    v_mfma_f32_32x32x16_bf16 v[16:31], v[40:43], v[36:39], v[16:31]
    s_waitcnt lgkmcnt(0)
    v_mfma_f32_32x32x16_bf16 v[184:199], v[64:67], v[52:55], v[184:199]
    s_barrier
    ds_write_b128 v161, v[168:171]
    ds_read_b128 v[32:35], v248 offset:45056
    ds_read_b64_tr_b16 v[40:41], v1 offset:49152
    ds_read_b64_tr_b16 v[42:43], v1 offset:49408
    v_mfma_f32_32x32x16_bf16 v[200:215], v[64:67], v[56:59], v[200:215]
    ds_read_b128 v[36:39], v248 offset:49152
    ds_read_b128 v[44:47], v249 offset:45056
    ds_read_b128 v[48:51], v249 offset:49152
    v_mfma_f32_32x32x16_bf16 v[216:231], v[52:55], v[68:71], v[216:231]
    ds_read_b64_tr_b16 v[72:73], v1 offset:50176
    ds_read_b64_tr_b16 v[74:75], v1 offset:50432
    ds_read_b128 v[76:79], v250 offset:45056
    v_mfma_f32_32x32x16_bf16 v[232:247], v[56:59], v[68:71], v[232:247]
    ds_read_b64_tr_b16 v[164:165], v1 offset:51200
    ds_read_b64_tr_b16 v[166:167], v1 offset:51456
    ds_read_b128 v[160:163], v250 offset:49152
    v_mfma_f32_32x32x16_bf16 v[144:159], v[60:63], v[52:55], v[144:159]
    ds_read_b64_tr_b16 v[64:65], v1 offset:52224
    ds_read_b64_tr_b16 v[66:67], v1 offset:52480
    ds_read_b64_tr_b16 v[68:69], v1 offset:53248
    ds_read_b64_tr_b16 v[70:71], v1 offset:53504
    v_mfma_f32_32x32x16_bf16 v[16:31], v[60:63], v[56:59], v[16:31]
    s_waitcnt lgkmcnt(13)
    v_mfma_f32_32x32x16_bf16 v[184:199], v[40:43], v[32:35], v[184:199]
    ds_read_b128 v[52:55], v251 offset:45056
    ds_read_b128 v[56:59], v251 offset:49152
    s_waitcnt lgkmcnt(14)
    v_mfma_f32_32x32x16_bf16 v[200:215], v[40:43], v[36:39], v[200:215]
    ds_read_b64_tr_b16 v[60:61], v1 offset:54272
    ds_read_b64_tr_b16 v[62:63], v1 offset:54528
    s_waitcnt lgkmcnt(12)
    v_mfma_f32_32x32x16_bf16 v[184:199], v[72:75], v[44:47], v[184:199]
    ds_read_b64_tr_b16 v[40:41], v1 offset:55296
    ds_read_b64_tr_b16 v[42:43], v1 offset:55552
    s_mov_b32 s40, 0x3eb8aa3b
    s_mov_b32 s41, s40
    s_and_b32 s45, s17, 3
    s_cmp_eq_u32 s45, 2
    s_cselect_b32 s46, 0, 0x80000000
    s_lshl_b32 s47, s16, 5
    s_sub_u32 s47, s46, s47
    v_add_u32 v249, s47, v5
    v_add_u32 v250, s47, v6
    v_mfma_f32_32x32x16_bf16 v[200:215], v[72:75], v[48:51], v[200:215]
    s_waitcnt lgkmcnt(11)
    v_mfma_f32_32x32x16_bf16 v[184:199], v[164:167], v[76:79], v[184:199]
    ds_read_b64_tr_b16 v[72:73], v1 offset:56320
    ds_read_b64_tr_b16 v[74:75], v1 offset:56576
    s_waitcnt lgkmcnt(12)
    v_mfma_f32_32x32x16_bf16 v[200:215], v[164:167], v[160:163], v[200:215]
    s_waitcnt lgkmcnt(7)
    v_mfma_f32_32x32x16_bf16 v[184:199], v[64:67], v[52:55], v[184:199]
    ds_read_b64_tr_b16 v[164:165], v3 offset:45056
    ds_read_b64_tr_b16 v[166:167], v3 offset:45312
    v_xor_b32 v248, 0x800, v7
    v_mov_b32 v1, 158720
    s_lshl_b32 s45, s17, 9
    v_mov_b32 v4, s45
    v_cmp_eq_u32 vcc, 0, v0
    v_mov_b32 v2, 0x80000000
    s_nop 0
    v_cndmask_b32 v4, v2, v4, vcc
    v_or_b32 v4, s46, v4
    s_waitcnt lgkmcnt(8)
    v_mfma_f32_32x32x16_bf16 v[200:215], v[64:67], v[56:59], v[200:215]
    v_mfma_f32_32x32x16_bf16 v[216:231], v[32:35], v[68:71], v[216:231]
    ds_read_b64_tr_b16 v[64:65], v3 offset:46080
    ds_read_b64_tr_b16 v[66:67], v3 offset:46336
    v_pk_mul_f32 v[184:185], v[184:185], s[40:41]
    v_pk_mul_f32 v[186:187], v[186:187], s[40:41]
    v_pk_mul_f32 v[188:189], v[188:189], s[40:41]
    v_pk_mul_f32 v[190:191], v[190:191], s[40:41]
    v_cvt_pk_bf16_f32 v184, v184, v185
    v_cvt_pk_bf16_f32 v185, v186, v187
    v_mfma_f32_32x32x16_bf16 v[232:247], v[36:39], v[68:71], v[232:247]
    v_cvt_pk_bf16_f32 v186, v188, v189
    v_cvt_pk_bf16_f32 v187, v190, v191
    buffer_store_dwordx4 v[184:187], v249, s[28:31], s42 offen offset:0 sc1
    ds_write_b128 v5, v[184:187] offset:0
    s_waitcnt lgkmcnt(9)
    v_mfma_f32_32x32x16_bf16 v[216:231], v[44:47], v[60:63], v[216:231]
    ds_read_b64_tr_b16 v[68:69], v3 offset:47104
    ds_read_b64_tr_b16 v[70:71], v3 offset:47360
    v_pk_mul_f32 v[192:193], v[192:193], s[40:41]
    v_pk_mul_f32 v[194:195], v[194:195], s[40:41]
    v_pk_mul_f32 v[196:197], v[196:197], s[40:41]
    v_pk_mul_f32 v[198:199], v[198:199], s[40:41]
    v_cvt_pk_bf16_f32 v192, v192, v193
    v_cvt_pk_bf16_f32 v193, v194, v195
    v_mfma_f32_32x32x16_bf16 v[232:247], v[48:51], v[60:63], v[232:247]
    v_cvt_pk_bf16_f32 v194, v196, v197
    v_cvt_pk_bf16_f32 v195, v198, v199
    buffer_store_dwordx4 v[192:195], v249, s[28:31], s42 offen offset:2048 sc1
    ds_write_b128 v5, v[192:195] offset:2048
    s_waitcnt lgkmcnt(10)
    v_mfma_f32_32x32x16_bf16 v[216:231], v[76:79], v[40:43], v[216:231]
    ds_read_b64_tr_b16 v[60:61], v3 offset:48128
    ds_read_b64_tr_b16 v[62:63], v3 offset:48384
    v_pk_mul_f32 v[200:201], v[200:201], s[40:41]
    v_pk_mul_f32 v[202:203], v[202:203], s[40:41]
    v_pk_mul_f32 v[204:205], v[204:205], s[40:41]
    v_pk_mul_f32 v[206:207], v[206:207], s[40:41]
    v_cvt_pk_bf16_f32 v200, v200, v201
    v_cvt_pk_bf16_f32 v201, v202, v203
    v_mfma_f32_32x32x16_bf16 v[232:247], v[160:163], v[40:43], v[232:247]
    v_cvt_pk_bf16_f32 v202, v204, v205
    v_cvt_pk_bf16_f32 v203, v206, v207
    buffer_store_dwordx4 v[200:203], v249, s[28:31], s43 offen offset:0 sc1
    ds_write_b128 v5, v[200:203] offset:4112
    s_waitcnt lgkmcnt(11)
    v_mfma_f32_32x32x16_bf16 v[216:231], v[52:55], v[72:75], v[216:231]
    v_pk_mul_f32 v[208:209], v[208:209], s[40:41]
    v_pk_mul_f32 v[210:211], v[210:211], s[40:41]
    v_pk_mul_f32 v[212:213], v[212:213], s[40:41]
    v_pk_mul_f32 v[214:215], v[214:215], s[40:41]
    v_cvt_pk_bf16_f32 v208, v208, v209
    v_cvt_pk_bf16_f32 v209, v210, v211
    v_mfma_f32_32x32x16_bf16 v[232:247], v[56:59], v[72:75], v[232:247]
    v_cvt_pk_bf16_f32 v210, v212, v213
    v_cvt_pk_bf16_f32 v211, v214, v215
    buffer_store_dwordx4 v[208:211], v249, s[28:31], s43 offen offset:2048 sc1
    ds_write_b128 v5, v[208:211] offset:6160
    s_waitcnt lgkmcnt(10)
    v_mfma_f32_32x32x16_bf16 v[144:159], v[164:167], v[32:35], v[144:159]
    v_cvt_pk_bf16_f32 v216, v216, v217
    v_cvt_pk_bf16_f32 v217, v218, v219
    v_cvt_pk_bf16_f32 v218, v220, v221
    v_cvt_pk_bf16_f32 v219, v222, v223
    v_mfma_f32_32x32x16_bf16 v[16:31], v[164:167], v[36:39], v[16:31]
    buffer_store_dwordx4 v[216:219], v250, s[28:31], s42 offen offset:1024 sc1
    ds_write_b128 v6, v[216:219] offset:1024
    v_cvt_pk_bf16_f32 v224, v224, v225
    v_cvt_pk_bf16_f32 v225, v226, v227
    s_waitcnt lgkmcnt(9)
    v_mfma_f32_32x32x16_bf16 v[144:159], v[64:67], v[44:47], v[144:159]
    v_cvt_pk_bf16_f32 v226, v228, v229
    v_cvt_pk_bf16_f32 v227, v230, v231
    buffer_store_dwordx4 v[224:227], v250, s[28:31], s42 offen offset:1280 sc1
    ds_write_b128 v6, v[224:227] offset:1280
    v_mfma_f32_32x32x16_bf16 v[16:31], v[64:67], v[48:51], v[16:31]
    v_cvt_pk_bf16_f32 v232, v232, v233
    v_cvt_pk_bf16_f32 v233, v234, v235
    v_cvt_pk_bf16_f32 v234, v236, v237
    v_cvt_pk_bf16_f32 v235, v238, v239
    s_waitcnt lgkmcnt(7)
    v_mfma_f32_32x32x16_bf16 v[144:159], v[68:71], v[76:79], v[144:159]
    buffer_store_dwordx4 v[232:235], v250, s[28:31], s43 offen offset:1024 sc1
    ds_write_b128 v6, v[232:235] offset:5136
    v_cvt_pk_bf16_f32 v240, v240, v241
    v_cvt_pk_bf16_f32 v241, v242, v243
    v_mfma_f32_32x32x16_bf16 v[16:31], v[68:71], v[160:163], v[16:31]
    v_cvt_pk_bf16_f32 v242, v244, v245
    v_cvt_pk_bf16_f32 v243, v246, v247
    buffer_store_dwordx4 v[240:243], v250, s[28:31], s43 offen offset:1280 sc1
    ds_write_b128 v6, v[240:243] offset:5392
    s_waitcnt lgkmcnt(6)
    v_mfma_f32_32x32x16_bf16 v[144:159], v[60:63], v[52:55], v[144:159]
    v_mov_b32 v72, 0
    v_mov_b32 v73, 0
    v_mov_b32 v74, 0
    v_mov_b32 v75, 0
    v_mfma_f32_32x32x16_bf16 v[16:31], v[60:63], v[56:59], v[16:31]
    v_mov_b32 v76, 0
    v_mov_b32 v77, 0
    v_mov_b32 v78, 0
    v_mov_b32 v79, 0
    s_nop 1
    v_cvt_pk_bf16_f32 v32, v152, v153
    v_cvt_pk_bf16_f32 v33, v154, v155
    v_cvt_pk_bf16_f32 v34, v156, v157
    v_cvt_pk_bf16_f32 v35, v158, v159
    ds_write_b128 v7, v[32:35]
    v_cvt_pk_bf16_f32 v144, v144, v145
    v_cvt_pk_bf16_f32 v145, v146, v147
    v_cvt_pk_bf16_f32 v146, v148, v149
    v_cvt_pk_bf16_f32 v147, v150, v151
    v_cvt_pk_bf16_f32 v36, v24, v25
    v_cvt_pk_bf16_f32 v37, v26, v27
    v_cvt_pk_bf16_f32 v38, v28, v29
    v_cvt_pk_bf16_f32 v39, v30, v31
    ds_write_b128 v7, v[36:39] offset:1024
    v_cvt_pk_bf16_f32 v148, v16, v17
    v_cvt_pk_bf16_f32 v149, v18, v19
    v_cvt_pk_bf16_f32 v150, v20, v21
    v_cvt_pk_bf16_f32 v151, v22, v23
    v_mov_b32 v7, v248
    s_waitcnt lgkmcnt(0)
    s_barrier
    ds_read_b128 v[160:163], v9
    ds_read_b128 v[152:155], v7
    ds_read_b128 v[156:159], v7 offset:1024
    ds_read_b128 v[168:171], v254 offset:1024
    ds_read_b128 v[172:175], v255 offset:1280
    ds_read_b64 v[2:3], v1
    s_mov_b32 s38, 0
    s_mov_b32 s39, 1
    s_mov_b32 s40, 8
    s_waitcnt lgkmcnt(5)
    v_mfma_f32_32x32x16_bf16 v[16:31], v[160:163], v[144:147], 0
    v_mfma_f32_32x32x16_bf16 v[32:47], v[160:163], v[148:151], 0
    s_waitcnt lgkmcnt(0)
    s_nop 10
    v_exp_f32 v16, v16
    v_exp_f32 v17, v17
    v_smfmac_f32_32x32x32_bf16 v[128:143], v[180:183], v[72:79], v8
    ds_read_b128 v[164:167], v9 offset:4112
    ds_read_b128 v[176:179], v254 offset:5136
    ds_read_b128 v[180:183], v255 offset:5392
    v_exp_f32 v18, v18
    v_exp_f32 v19, v19
    v_exp_f32 v20, v20
    v_exp_f32 v21, v21
    v_exp_f32 v22, v22
    v_mfma_f32_32x32x16_bf16 v[48:63], v[160:163], v[152:155], 0
    v_exp_f32 v23, v23
    v_exp_f32 v24, v24
    v_exp_f32 v25, v25
    v_exp_f32 v26, v26
    v_smfmac_f32_32x32x32_bf16 v[80:95], v[168:171], v[16:23], v8
    v_exp_f32 v27, v27
    v_exp_f32 v28, v28
    v_exp_f32 v29, v29
    v_exp_f32 v30, v30
    v_exp_f32 v31, v31
    v_exp_f32 v32, v32
    v_exp_f32 v33, v33
    v_smfmac_f32_32x32x32_bf16 v[80:95], v[172:175], v[24:31], v8
    v_exp_f32 v34, v34
    v_exp_f32 v35, v35
    v_exp_f32 v36, v36
    v_exp_f32 v37, v37
    v_exp_f32 v38, v38
    v_mfma_f32_32x32x16_bf16 v[64:79], v[160:163], v[156:159], 0
    v_exp_f32 v39, v39
    v_exp_f32 v40, v40
    v_exp_f32 v41, v41
    v_exp_f32 v42, v42
    v_smfmac_f32_32x32x32_bf16 v[96:111], v[168:171], v[32:39], v8
    v_exp_f32 v43, v43
    v_exp_f32 v44, v44
    v_exp_f32 v45, v45
    v_exp_f32 v46, v46
    v_exp_f32 v47, v47
    v_exp_f32 v48, v48
    v_exp_f32 v49, v49
    v_smfmac_f32_32x32x32_bf16 v[96:111], v[172:175], v[40:47], v8
    s_waitcnt lgkmcnt(0)
    v_exp_f32 v50, v50
    v_exp_f32 v51, v51
    v_exp_f32 v52, v52
    v_exp_f32 v53, v53
    v_exp_f32 v54, v54
    v_mfma_f32_32x32x16_bf16 v[16:31], v[164:167], v[144:147], 0
    v_exp_f32 v55, v55
    v_exp_f32 v56, v56
    v_exp_f32 v57, v57
    v_exp_f32 v58, v58
    v_smfmac_f32_32x32x32_bf16 v[112:127], v[168:171], v[48:55], v8
    v_exp_f32 v59, v59
    v_exp_f32 v60, v60
    v_exp_f32 v61, v61
    v_exp_f32 v62, v62
    v_exp_f32 v63, v63
    v_exp_f32 v64, v64
    v_exp_f32 v65, v65
    v_smfmac_f32_32x32x32_bf16 v[112:127], v[172:175], v[56:63], v8
    v_exp_f32 v66, v66
    v_exp_f32 v67, v67
    v_exp_f32 v68, v68
    v_exp_f32 v69, v69
    v_exp_f32 v70, v70
    v_mfma_f32_32x32x16_bf16 v[32:47], v[164:167], v[148:151], 0
    v_exp_f32 v71, v71
    v_exp_f32 v72, v72
    v_exp_f32 v73, v73
    v_exp_f32 v74, v74
    v_smfmac_f32_32x32x32_bf16 v[128:143], v[168:171], v[64:71], v8
    v_exp_f32 v75, v75
    v_exp_f32 v76, v76
    v_exp_f32 v77, v77
    v_exp_f32 v78, v78
    v_exp_f32 v79, v79
    v_exp_f32 v16, v16
    v_exp_f32 v17, v17
    v_smfmac_f32_32x32x32_bf16 v[128:143], v[172:175], v[72:79], v8
    ds_read_b128 v[160:163], v9 offset:8224
    ds_read_b128 v[168:171], v254 offset:9248
    ds_read_b128 v[172:175], v255 offset:9504
    v_exp_f32 v18, v18
    v_exp_f32 v19, v19
    v_exp_f32 v20, v20
    v_exp_f32 v21, v21
    v_exp_f32 v22, v22
    v_mfma_f32_32x32x16_bf16 v[48:63], v[164:167], v[152:155], 0
    v_exp_f32 v23, v23
    v_exp_f32 v24, v24
    v_exp_f32 v25, v25
    v_exp_f32 v26, v26
    v_smfmac_f32_32x32x32_bf16 v[80:95], v[176:179], v[16:23], v8
    v_exp_f32 v27, v27
    v_exp_f32 v28, v28
    v_exp_f32 v29, v29
    v_exp_f32 v30, v30
    v_exp_f32 v31, v31
    v_exp_f32 v32, v32
    v_exp_f32 v33, v33
    v_smfmac_f32_32x32x32_bf16 v[80:95], v[180:183], v[24:31], v8
    v_exp_f32 v34, v34
    v_exp_f32 v35, v35
    v_exp_f32 v36, v36
    v_exp_f32 v37, v37
    v_exp_f32 v38, v38
    v_mfma_f32_32x32x16_bf16 v[64:79], v[164:167], v[156:159], 0
    v_exp_f32 v39, v39
    v_exp_f32 v40, v40
    v_exp_f32 v41, v41
    v_exp_f32 v42, v42
    v_smfmac_f32_32x32x32_bf16 v[96:111], v[176:179], v[32:39], v8
    v_exp_f32 v43, v43
    v_exp_f32 v44, v44
    v_exp_f32 v45, v45
    v_exp_f32 v46, v46
    v_exp_f32 v47, v47
    v_exp_f32 v48, v48
    v_exp_f32 v49, v49
    v_smfmac_f32_32x32x32_bf16 v[96:111], v[180:183], v[40:47], v8
    s_waitcnt lgkmcnt(0)
    s_waitcnt vmcnt(0)
    v_exp_f32 v50, v50
    v_exp_f32 v51, v51
    v_exp_f32 v52, v52
    v_exp_f32 v53, v53
    v_exp_f32 v54, v54
    v_mfma_f32_32x32x16_bf16 v[16:31], v[160:163], v[144:147], 0
    buffer_store_dwordx2 v[2:3], v4, s[28:31], s44 offen sc1
    v_exp_f32 v55, v55
    v_exp_f32 v56, v56
    v_exp_f32 v57, v57
    v_exp_f32 v58, v58
    v_smfmac_f32_32x32x32_bf16 v[112:127], v[176:179], v[48:55], v8
    v_exp_f32 v59, v59
    v_exp_f32 v60, v60
    v_exp_f32 v61, v61
    v_exp_f32 v62, v62
    v_exp_f32 v63, v63
    v_exp_f32 v64, v64
    v_exp_f32 v65, v65
    v_smfmac_f32_32x32x32_bf16 v[112:127], v[180:183], v[56:63], v8
    v_exp_f32 v66, v66
    v_exp_f32 v67, v67
    v_exp_f32 v68, v68
    v_exp_f32 v69, v69
    v_exp_f32 v70, v70
    v_mfma_f32_32x32x16_bf16 v[32:47], v[160:163], v[148:151], 0
    v_exp_f32 v71, v71
    v_exp_f32 v72, v72
    v_exp_f32 v73, v73
    v_exp_f32 v74, v74
    v_smfmac_f32_32x32x32_bf16 v[128:143], v[176:179], v[64:71], v8
    v_exp_f32 v75, v75
    v_exp_f32 v76, v76
    v_exp_f32 v77, v77
    v_exp_f32 v78, v78
    v_exp_f32 v79, v79
    s_branch A_J2
.p2align 6
A_LOOP:
    v_exp_f32 v16, v16
    v_exp_f32 v17, v17
    v_smfmac_f32_32x32x32_bf16 v[128:143], v[180:183], v[72:79], v8
    ds_read_b128 v[164:167], v9 offset:4112
    ds_read_b128 v[176:179], v254 offset:5136
    ds_read_b128 v[180:183], v255 offset:5392
    v_exp_f32 v18, v18
    v_exp_f32 v19, v19
    v_exp_f32 v20, v20
    v_exp_f32 v21, v21
    v_exp_f32 v22, v22
    v_mfma_f32_32x32x16_bf16 v[48:63], v[160:163], v[152:155], 0
    v_exp_f32 v23, v23
    v_exp_f32 v24, v24
    v_exp_f32 v25, v25
    v_exp_f32 v26, v26
    v_smfmac_f32_32x32x32_bf16 v[80:95], v[168:171], v[16:23], v8
    v_exp_f32 v27, v27
    v_exp_f32 v28, v28
    v_exp_f32 v29, v29
    v_exp_f32 v30, v30
    v_exp_f32 v31, v31
    v_exp_f32 v32, v32
    v_exp_f32 v33, v33
    v_smfmac_f32_32x32x32_bf16 v[80:95], v[172:175], v[24:31], v8
    v_exp_f32 v34, v34
    v_exp_f32 v35, v35
    v_exp_f32 v36, v36
    v_exp_f32 v37, v37
    v_exp_f32 v38, v38
    v_mfma_f32_32x32x16_bf16 v[64:79], v[160:163], v[156:159], 0
    v_exp_f32 v39, v39
    v_exp_f32 v40, v40
    v_exp_f32 v41, v41
    v_exp_f32 v42, v42
    v_smfmac_f32_32x32x32_bf16 v[96:111], v[168:171], v[32:39], v8
    s_add_u32 s39, s39, 1
    v_exp_f32 v43, v43
    v_exp_f32 v44, v44
    v_exp_f32 v45, v45
    v_exp_f32 v46, v46
    v_exp_f32 v47, v47
    v_exp_f32 v48, v48
    v_exp_f32 v49, v49
    v_smfmac_f32_32x32x32_bf16 v[96:111], v[172:175], v[40:47], v8
    s_waitcnt lgkmcnt(0)
    v_exp_f32 v50, v50
    v_exp_f32 v51, v51
    v_exp_f32 v52, v52
    v_exp_f32 v53, v53
    v_exp_f32 v54, v54
    v_mfma_f32_32x32x16_bf16 v[16:31], v[164:167], v[144:147], 0
    v_exp_f32 v55, v55
    v_exp_f32 v56, v56
    v_exp_f32 v57, v57
    v_exp_f32 v58, v58
    v_smfmac_f32_32x32x32_bf16 v[112:127], v[168:171], v[48:55], v8
    s_min_u32 s39, s39, 7
    v_exp_f32 v59, v59
    v_exp_f32 v60, v60
    v_exp_f32 v61, v61
    v_exp_f32 v62, v62
    v_exp_f32 v63, v63
    v_exp_f32 v64, v64
    v_exp_f32 v65, v65
    v_smfmac_f32_32x32x32_bf16 v[112:127], v[172:175], v[56:63], v8
    v_exp_f32 v66, v66
    v_exp_f32 v67, v67
    v_exp_f32 v68, v68
    v_exp_f32 v69, v69
    v_exp_f32 v70, v70
    v_mfma_f32_32x32x16_bf16 v[32:47], v[164:167], v[148:151], 0
    v_exp_f32 v71, v71
    v_exp_f32 v72, v72
    v_exp_f32 v73, v73
    v_exp_f32 v74, v74
    v_smfmac_f32_32x32x32_bf16 v[128:143], v[168:171], v[64:71], v8
    v_exp_f32 v75, v75
    v_exp_f32 v76, v76
    v_exp_f32 v77, v77
    v_exp_f32 v78, v78
    v_exp_f32 v79, v79
    v_exp_f32 v16, v16
    v_exp_f32 v17, v17
    v_smfmac_f32_32x32x32_bf16 v[128:143], v[172:175], v[72:79], v8
    ds_read_b128 v[160:163], v9 offset:8224
    ds_read_b128 v[168:171], v254 offset:9248
    ds_read_b128 v[172:175], v255 offset:9504
    v_exp_f32 v18, v18
    v_exp_f32 v19, v19
    v_exp_f32 v20, v20
    v_exp_f32 v21, v21
    v_exp_f32 v22, v22
    v_mfma_f32_32x32x16_bf16 v[48:63], v[164:167], v[152:155], 0
    v_exp_f32 v23, v23
    v_exp_f32 v24, v24
    v_exp_f32 v25, v25
    v_exp_f32 v26, v26
    v_smfmac_f32_32x32x32_bf16 v[80:95], v[176:179], v[16:23], v8
    v_exp_f32 v27, v27
    v_exp_f32 v28, v28
    v_exp_f32 v29, v29
    v_exp_f32 v30, v30
    v_exp_f32 v31, v31
    v_exp_f32 v32, v32
    v_exp_f32 v33, v33
    v_smfmac_f32_32x32x32_bf16 v[80:95], v[180:183], v[24:31], v8
    v_exp_f32 v34, v34
    v_exp_f32 v35, v35
    v_exp_f32 v36, v36
    v_exp_f32 v37, v37
    v_exp_f32 v38, v38
    v_mfma_f32_32x32x16_bf16 v[64:79], v[164:167], v[156:159], 0
    v_exp_f32 v39, v39
    v_exp_f32 v40, v40
    v_exp_f32 v41, v41
    v_exp_f32 v42, v42
    v_smfmac_f32_32x32x32_bf16 v[96:111], v[176:179], v[32:39], v8
    v_exp_f32 v43, v43
    v_exp_f32 v44, v44
    v_exp_f32 v45, v45
    v_exp_f32 v46, v46
    v_exp_f32 v47, v47
    v_exp_f32 v48, v48
    v_exp_f32 v49, v49
    v_smfmac_f32_32x32x32_bf16 v[96:111], v[180:183], v[40:47], v8
    s_waitcnt lgkmcnt(0)
    v_exp_f32 v50, v50
    v_exp_f32 v51, v51
    v_exp_f32 v52, v52
    v_exp_f32 v53, v53
    v_exp_f32 v54, v54
    v_mfma_f32_32x32x16_bf16 v[16:31], v[160:163], v[144:147], 0
    v_exp_f32 v55, v55
    v_exp_f32 v56, v56
    v_exp_f32 v57, v57
    v_exp_f32 v58, v58
    v_smfmac_f32_32x32x32_bf16 v[112:127], v[176:179], v[48:55], v8
    v_exp_f32 v59, v59
    v_exp_f32 v60, v60
    v_exp_f32 v61, v61
    v_exp_f32 v62, v62
    v_exp_f32 v63, v63
    v_exp_f32 v64, v64
    v_exp_f32 v65, v65
    v_smfmac_f32_32x32x32_bf16 v[112:127], v[180:183], v[56:63], v8
    v_exp_f32 v66, v66
    v_exp_f32 v67, v67
    v_exp_f32 v68, v68
    v_exp_f32 v69, v69
    v_exp_f32 v70, v70
    v_mfma_f32_32x32x16_bf16 v[32:47], v[160:163], v[148:151], 0
    v_exp_f32 v71, v71
    v_exp_f32 v72, v72
    v_exp_f32 v73, v73
    v_exp_f32 v74, v74
    v_smfmac_f32_32x32x32_bf16 v[128:143], v[176:179], v[64:71], v8
    v_exp_f32 v75, v75
    v_exp_f32 v76, v76
    v_exp_f32 v77, v77
    v_exp_f32 v78, v78
    v_exp_f32 v79, v79
A_J2:
    v_exp_f32 v16, v16
    v_exp_f32 v17, v17
    v_smfmac_f32_32x32x32_bf16 v[128:143], v[180:183], v[72:79], v8
    ds_read_b128 v[164:167], v9 offset:12336
    ds_read_b128 v[176:179], v254 offset:13360
    ds_read_b128 v[180:183], v255 offset:13616
    v_exp_f32 v18, v18
    v_exp_f32 v19, v19
    v_exp_f32 v20, v20
    v_exp_f32 v21, v21
    v_exp_f32 v22, v22
    v_mfma_f32_32x32x16_bf16 v[48:63], v[160:163], v[152:155], 0
    v_exp_f32 v23, v23
    v_exp_f32 v24, v24
    v_exp_f32 v25, v25
    v_exp_f32 v26, v26
    v_smfmac_f32_32x32x32_bf16 v[80:95], v[168:171], v[16:23], v8
    v_exp_f32 v27, v27
    v_exp_f32 v28, v28
    v_exp_f32 v29, v29
    v_exp_f32 v30, v30
    v_exp_f32 v31, v31
    v_exp_f32 v32, v32
    v_exp_f32 v33, v33
    v_smfmac_f32_32x32x32_bf16 v[80:95], v[172:175], v[24:31], v8
    v_exp_f32 v34, v34
    v_exp_f32 v35, v35
    v_exp_f32 v36, v36
    v_exp_f32 v37, v37
    v_exp_f32 v38, v38
    v_mfma_f32_32x32x16_bf16 v[64:79], v[160:163], v[156:159], 0
    v_exp_f32 v39, v39
    v_exp_f32 v40, v40
    v_exp_f32 v41, v41
    v_exp_f32 v42, v42
    v_smfmac_f32_32x32x32_bf16 v[96:111], v[168:171], v[32:39], v8
    v_exp_f32 v43, v43
    v_exp_f32 v44, v44
    v_exp_f32 v45, v45
    v_exp_f32 v46, v46
    v_exp_f32 v47, v47
    v_exp_f32 v48, v48
    v_exp_f32 v49, v49
    v_smfmac_f32_32x32x32_bf16 v[96:111], v[172:175], v[40:47], v8
    s_waitcnt lgkmcnt(0)
    v_exp_f32 v50, v50
    v_exp_f32 v51, v51
    v_exp_f32 v52, v52
    v_exp_f32 v53, v53
    v_exp_f32 v54, v54
    v_mfma_f32_32x32x16_bf16 v[16:31], v[164:167], v[144:147], 0
    v_exp_f32 v55, v55
    v_exp_f32 v56, v56
    v_exp_f32 v57, v57
    v_exp_f32 v58, v58
    v_smfmac_f32_32x32x32_bf16 v[112:127], v[168:171], v[48:55], v8
    v_exp_f32 v59, v59
    v_exp_f32 v60, v60
    v_exp_f32 v61, v61
    v_exp_f32 v62, v62
    v_exp_f32 v63, v63
    v_exp_f32 v64, v64
    v_exp_f32 v65, v65
    v_smfmac_f32_32x32x32_bf16 v[112:127], v[172:175], v[56:63], v8
    v_exp_f32 v66, v66
    v_exp_f32 v67, v67
    v_exp_f32 v68, v68
    v_exp_f32 v69, v69
    v_exp_f32 v70, v70
    v_mfma_f32_32x32x16_bf16 v[32:47], v[164:167], v[148:151], 0
    v_exp_f32 v71, v71
    v_exp_f32 v72, v72
    v_exp_f32 v73, v73
    v_exp_f32 v74, v74
    v_smfmac_f32_32x32x32_bf16 v[128:143], v[168:171], v[64:71], v8
    v_exp_f32 v75, v75
    v_exp_f32 v76, v76
    v_exp_f32 v77, v77
    v_exp_f32 v78, v78
    v_exp_f32 v79, v79
    v_exp_f32 v16, v16
    v_exp_f32 v17, v17
    v_smfmac_f32_32x32x32_bf16 v[128:143], v[172:175], v[72:79], v8
    ds_read_b128 v[160:163], v9 offset:16448
    ds_read_b128 v[168:171], v254 offset:17472
    ds_read_b128 v[172:175], v255 offset:17728
    v_exp_f32 v18, v18
    v_exp_f32 v19, v19
    v_exp_f32 v20, v20
    v_exp_f32 v21, v21
    v_exp_f32 v22, v22
    v_mfma_f32_32x32x16_bf16 v[48:63], v[164:167], v[152:155], 0
    v_exp_f32 v23, v23
    v_exp_f32 v24, v24
    v_exp_f32 v25, v25
    v_exp_f32 v26, v26
    v_smfmac_f32_32x32x32_bf16 v[80:95], v[176:179], v[16:23], v8
    v_exp_f32 v27, v27
    v_exp_f32 v28, v28
    v_exp_f32 v29, v29
    v_exp_f32 v30, v30
    v_exp_f32 v31, v31
    v_exp_f32 v32, v32
    v_exp_f32 v33, v33
    v_smfmac_f32_32x32x32_bf16 v[80:95], v[180:183], v[24:31], v8
    v_exp_f32 v34, v34
    v_exp_f32 v35, v35
    v_exp_f32 v36, v36
    v_exp_f32 v37, v37
    v_exp_f32 v38, v38
    v_mfma_f32_32x32x16_bf16 v[64:79], v[164:167], v[156:159], 0
    v_exp_f32 v39, v39
    v_exp_f32 v40, v40
    v_exp_f32 v41, v41
    v_exp_f32 v42, v42
    v_smfmac_f32_32x32x32_bf16 v[96:111], v[176:179], v[32:39], v8
    v_exp_f32 v43, v43
    v_exp_f32 v44, v44
    v_exp_f32 v45, v45
    v_exp_f32 v46, v46
    v_exp_f32 v47, v47
    v_exp_f32 v48, v48
    v_exp_f32 v49, v49
    v_smfmac_f32_32x32x32_bf16 v[96:111], v[180:183], v[40:47], v8
    s_waitcnt lgkmcnt(0)
    v_exp_f32 v50, v50
    v_exp_f32 v51, v51
    v_exp_f32 v52, v52
    v_exp_f32 v53, v53
    v_exp_f32 v54, v54
    v_mfma_f32_32x32x16_bf16 v[16:31], v[160:163], v[144:147], 0
    v_exp_f32 v55, v55
    v_exp_f32 v56, v56
    v_exp_f32 v57, v57
    v_exp_f32 v58, v58
    v_smfmac_f32_32x32x32_bf16 v[112:127], v[176:179], v[48:55], v8
    v_exp_f32 v59, v59
    v_exp_f32 v60, v60
    v_exp_f32 v61, v61
    v_exp_f32 v62, v62
    v_exp_f32 v63, v63
    v_exp_f32 v64, v64
    v_exp_f32 v65, v65
    v_smfmac_f32_32x32x32_bf16 v[112:127], v[180:183], v[56:63], v8
    v_exp_f32 v66, v66
    v_exp_f32 v67, v67
    v_exp_f32 v68, v68
    v_exp_f32 v69, v69
    v_exp_f32 v70, v70
    v_mfma_f32_32x32x16_bf16 v[32:47], v[160:163], v[148:151], 0
    v_exp_f32 v71, v71
    v_exp_f32 v72, v72
    v_exp_f32 v73, v73
    v_exp_f32 v74, v74
    v_smfmac_f32_32x32x32_bf16 v[128:143], v[176:179], v[64:71], v8
    v_exp_f32 v75, v75
    v_exp_f32 v76, v76
    v_exp_f32 v77, v77
    v_exp_f32 v78, v78
    v_exp_f32 v79, v79
    v_exp_f32 v16, v16
    v_exp_f32 v17, v17
    v_smfmac_f32_32x32x32_bf16 v[128:143], v[180:183], v[72:79], v8
    ds_read_b128 v[164:167], v9 offset:20560
    ds_read_b128 v[176:179], v254 offset:21584
    ds_read_b128 v[180:183], v255 offset:21840
    v_exp_f32 v18, v18
    v_exp_f32 v19, v19
    v_exp_f32 v20, v20
    v_exp_f32 v21, v21
    v_exp_f32 v22, v22
    v_mfma_f32_32x32x16_bf16 v[48:63], v[160:163], v[152:155], 0
    v_exp_f32 v23, v23
    v_exp_f32 v24, v24
    v_exp_f32 v25, v25
    v_exp_f32 v26, v26
    v_smfmac_f32_32x32x32_bf16 v[80:95], v[168:171], v[16:23], v8
    v_exp_f32 v27, v27
    v_exp_f32 v28, v28
    v_exp_f32 v29, v29
    v_exp_f32 v30, v30
    v_exp_f32 v31, v31
    v_exp_f32 v32, v32
    v_exp_f32 v33, v33
    v_smfmac_f32_32x32x32_bf16 v[80:95], v[172:175], v[24:31], v8
    v_exp_f32 v34, v34
    v_exp_f32 v35, v35
    v_exp_f32 v36, v36
    v_exp_f32 v37, v37
    v_exp_f32 v38, v38
    v_mfma_f32_32x32x16_bf16 v[64:79], v[160:163], v[156:159], 0
    v_exp_f32 v39, v39
    v_exp_f32 v40, v40
    v_exp_f32 v41, v41
    v_exp_f32 v42, v42
    v_smfmac_f32_32x32x32_bf16 v[96:111], v[168:171], v[32:39], v8
    v_exp_f32 v43, v43
    v_exp_f32 v44, v44
    v_exp_f32 v45, v45
    v_exp_f32 v46, v46
    v_exp_f32 v47, v47
    v_exp_f32 v48, v48
    v_exp_f32 v49, v49
    v_smfmac_f32_32x32x32_bf16 v[96:111], v[172:175], v[40:47], v8
    s_waitcnt lgkmcnt(0)
    v_exp_f32 v50, v50
    v_exp_f32 v51, v51
    v_exp_f32 v52, v52
    v_exp_f32 v53, v53
    v_exp_f32 v54, v54
    v_mfma_f32_32x32x16_bf16 v[16:31], v[164:167], v[144:147], 0
    v_exp_f32 v55, v55
    v_exp_f32 v56, v56
    v_exp_f32 v57, v57
    v_exp_f32 v58, v58
    v_smfmac_f32_32x32x32_bf16 v[112:127], v[168:171], v[48:55], v8
    v_exp_f32 v59, v59
    v_exp_f32 v60, v60
    v_exp_f32 v61, v61
    v_exp_f32 v62, v62
    v_exp_f32 v63, v63
    v_exp_f32 v64, v64
    v_exp_f32 v65, v65
    v_smfmac_f32_32x32x32_bf16 v[112:127], v[172:175], v[56:63], v8
    v_exp_f32 v66, v66
    v_exp_f32 v67, v67
    v_exp_f32 v68, v68
    v_exp_f32 v69, v69
    v_exp_f32 v70, v70
    v_mfma_f32_32x32x16_bf16 v[32:47], v[164:167], v[148:151], 0
    v_exp_f32 v71, v71
    v_exp_f32 v72, v72
    v_exp_f32 v73, v73
    v_exp_f32 v74, v74
    v_smfmac_f32_32x32x32_bf16 v[128:143], v[168:171], v[64:71], v8
    v_exp_f32 v75, v75
    v_exp_f32 v76, v76
    v_exp_f32 v77, v77
    v_exp_f32 v78, v78
    v_exp_f32 v79, v79
    v_exp_f32 v16, v16
    v_exp_f32 v17, v17
    v_smfmac_f32_32x32x32_bf16 v[128:143], v[172:175], v[72:79], v8
    ds_read_b128 v[160:163], v9 offset:24672
    ds_read_b128 v[168:171], v254 offset:25696
    ds_read_b128 v[172:175], v255 offset:25952
    v_exp_f32 v18, v18
    v_exp_f32 v19, v19
    v_exp_f32 v20, v20
    v_exp_f32 v21, v21
    v_exp_f32 v22, v22
    v_mfma_f32_32x32x16_bf16 v[48:63], v[164:167], v[152:155], 0
    v_exp_f32 v23, v23
    v_exp_f32 v24, v24
    v_exp_f32 v25, v25
    v_exp_f32 v26, v26
    v_smfmac_f32_32x32x32_bf16 v[80:95], v[176:179], v[16:23], v8
    v_exp_f32 v27, v27
    v_exp_f32 v28, v28
    v_exp_f32 v29, v29
    v_exp_f32 v30, v30
    v_exp_f32 v31, v31
    v_exp_f32 v32, v32
    v_exp_f32 v33, v33
    v_smfmac_f32_32x32x32_bf16 v[80:95], v[180:183], v[24:31], v8
    v_exp_f32 v34, v34
    v_exp_f32 v35, v35
    v_exp_f32 v36, v36
    v_exp_f32 v37, v37
    v_exp_f32 v38, v38
    v_mfma_f32_32x32x16_bf16 v[64:79], v[164:167], v[156:159], 0
    v_exp_f32 v39, v39
    v_exp_f32 v40, v40
    v_exp_f32 v41, v41
    v_exp_f32 v42, v42
    v_smfmac_f32_32x32x32_bf16 v[96:111], v[176:179], v[32:39], v8
    s_add_u32 s38, s38, 32896
    v_exp_f32 v43, v43
    v_exp_f32 v44, v44
    v_exp_f32 v45, v45
    v_exp_f32 v46, v46
    v_exp_f32 v47, v47
    v_exp_f32 v48, v48
    v_exp_f32 v49, v49
    v_smfmac_f32_32x32x32_bf16 v[96:111], v[180:183], v[40:47], v8
    s_waitcnt lgkmcnt(0)
    v_exp_f32 v50, v50
    v_exp_f32 v51, v51
    v_exp_f32 v52, v52
    v_exp_f32 v53, v53
    v_exp_f32 v54, v54
    v_mfma_f32_32x32x16_bf16 v[16:31], v[160:163], v[144:147], 0
    v_exp_f32 v55, v55
    v_exp_f32 v56, v56
    v_exp_f32 v57, v57
    v_exp_f32 v58, v58
    v_smfmac_f32_32x32x32_bf16 v[112:127], v[176:179], v[48:55], v8
    s_cmp_eq_u32 s38, 131584
    v_exp_f32 v59, v59
    v_exp_f32 v60, v60
    v_exp_f32 v61, v61
    v_exp_f32 v62, v62
    v_exp_f32 v63, v63
    v_exp_f32 v64, v64
    v_exp_f32 v65, v65
    v_smfmac_f32_32x32x32_bf16 v[112:127], v[180:183], v[56:63], v8
    s_cselect_b32 s38, 0, s38
    v_exp_f32 v66, v66
    v_exp_f32 v67, v67
    v_exp_f32 v68, v68
    v_exp_f32 v69, v69
    v_exp_f32 v70, v70
    v_mfma_f32_32x32x16_bf16 v[32:47], v[160:163], v[148:151], 0
    v_exp_f32 v71, v71
    v_exp_f32 v72, v72
    v_exp_f32 v73, v73
    v_exp_f32 v74, v74
    v_smfmac_f32_32x32x32_bf16 v[128:143], v[176:179], v[64:71], v8
    v_exp_f32 v75, v75
    v_exp_f32 v76, v76
    v_exp_f32 v77, v77
    v_exp_f32 v78, v78
    v_exp_f32 v79, v79
    v_exp_f32 v16, v16
    v_exp_f32 v17, v17
    v_smfmac_f32_32x32x32_bf16 v[128:143], v[180:183], v[72:79], v8
    ds_read_b128 v[164:167], v9 offset:28784
    ds_read_b128 v[176:179], v254 offset:29808
    ds_read_b128 v[180:183], v255 offset:30064
    v_exp_f32 v18, v18
    v_exp_f32 v19, v19
    v_exp_f32 v20, v20
    v_exp_f32 v21, v21
    v_exp_f32 v22, v22
    v_mfma_f32_32x32x16_bf16 v[48:63], v[160:163], v[152:155], 0
    v_exp_f32 v23, v23
    v_exp_f32 v24, v24
    v_exp_f32 v25, v25
    v_exp_f32 v26, v26
    v_smfmac_f32_32x32x32_bf16 v[80:95], v[168:171], v[16:23], v8
    v_exp_f32 v27, v27
    v_exp_f32 v28, v28
    v_exp_f32 v29, v29
    v_exp_f32 v30, v30
    v_exp_f32 v31, v31
    v_exp_f32 v32, v32
    v_exp_f32 v33, v33
    v_smfmac_f32_32x32x32_bf16 v[80:95], v[172:175], v[24:31], v8
    v_exp_f32 v34, v34
    v_exp_f32 v35, v35
    v_exp_f32 v36, v36
    v_exp_f32 v37, v37
    v_exp_f32 v38, v38
    v_mfma_f32_32x32x16_bf16 v[64:79], v[160:163], v[156:159], 0
    v_exp_f32 v39, v39
    v_exp_f32 v40, v40
    v_exp_f32 v41, v41
    v_exp_f32 v42, v42
    v_smfmac_f32_32x32x32_bf16 v[96:111], v[168:171], v[32:39], v8
    v_add_u32 v254, s38, v252
    v_exp_f32 v43, v43
    v_exp_f32 v44, v44
    v_exp_f32 v45, v45
    v_exp_f32 v46, v46
    v_exp_f32 v47, v47
    v_exp_f32 v48, v48
    v_exp_f32 v49, v49
    v_smfmac_f32_32x32x32_bf16 v[96:111], v[172:175], v[40:47], v8
    s_waitcnt lgkmcnt(0)
    v_exp_f32 v50, v50
    v_exp_f32 v51, v51
    v_exp_f32 v52, v52
    v_exp_f32 v53, v53
    v_exp_f32 v54, v54
    v_mfma_f32_32x32x16_bf16 v[16:31], v[164:167], v[144:147], 0
    v_exp_f32 v55, v55
    v_exp_f32 v56, v56
    v_exp_f32 v57, v57
    v_exp_f32 v58, v58
    v_smfmac_f32_32x32x32_bf16 v[112:127], v[168:171], v[48:55], v8
    ds_add_u32 v13, v14
    v_exp_f32 v59, v59
    v_exp_f32 v60, v60
    v_exp_f32 v61, v61
    v_exp_f32 v62, v62
    v_exp_f32 v63, v63
    v_exp_f32 v64, v64
    v_exp_f32 v65, v65
    v_smfmac_f32_32x32x32_bf16 v[112:127], v[172:175], v[56:63], v8
    v_add_u32 v255, s38, v253
    v_exp_f32 v66, v66
    v_exp_f32 v67, v67
    v_exp_f32 v68, v68
    v_exp_f32 v69, v69
    v_exp_f32 v70, v70
    v_mfma_f32_32x32x16_bf16 v[32:47], v[164:167], v[148:151], 0
    v_add_u32 v9, s38, v10
    v_exp_f32 v71, v71
    v_exp_f32 v72, v72
    v_exp_f32 v73, v73
    v_exp_f32 v74, v74
    v_smfmac_f32_32x32x32_bf16 v[128:143], v[168:171], v[64:71], v8
    ds_read_b32 v12, v11
    v_exp_f32 v75, v75
    v_exp_f32 v76, v76
    v_exp_f32 v77, v77
    v_exp_f32 v78, v78
    v_exp_f32 v79, v79
    v_exp_f32 v16, v16
    v_exp_f32 v17, v17
    v_smfmac_f32_32x32x32_bf16 v[128:143], v[172:175], v[72:79], v8
    s_waitcnt lgkmcnt(0)
    v_exp_f32 v18, v18
    v_exp_f32 v19, v19
    v_exp_f32 v20, v20
    v_exp_f32 v21, v21
    v_exp_f32 v22, v22
    v_mfma_f32_32x32x16_bf16 v[48:63], v[164:167], v[152:155], 0
    v_cmp_gt_u32 vcc, s39, v12
    v_exp_f32 v23, v23
    v_exp_f32 v24, v24
    v_exp_f32 v25, v25
    v_exp_f32 v26, v26
    v_smfmac_f32_32x32x32_bf16 v[80:95], v[176:179], v[16:23], v8
    s_cbranch_vccnz A_WAIT
A_BACK:
    ds_read_b128 v[160:163], v9 offset:0
    v_exp_f32 v27, v27
    v_exp_f32 v28, v28
    v_exp_f32 v29, v29
    v_exp_f32 v30, v30
    v_exp_f32 v31, v31
    v_exp_f32 v32, v32
    v_exp_f32 v33, v33
    v_smfmac_f32_32x32x32_bf16 v[80:95], v[180:183], v[24:31], v8
    ds_read_b128 v[168:171], v254 offset:1024
    v_exp_f32 v34, v34
    v_exp_f32 v35, v35
    v_exp_f32 v36, v36
    v_exp_f32 v37, v37
    v_exp_f32 v38, v38
    v_mfma_f32_32x32x16_bf16 v[64:79], v[164:167], v[156:159], 0
    v_exp_f32 v39, v39
    v_exp_f32 v40, v40
    v_exp_f32 v41, v41
    v_exp_f32 v42, v42
    v_smfmac_f32_32x32x32_bf16 v[96:111], v[176:179], v[32:39], v8
    ds_read_b128 v[172:175], v255 offset:1280
    v_exp_f32 v43, v43
    v_exp_f32 v44, v44
    v_exp_f32 v45, v45
    v_exp_f32 v46, v46
    v_exp_f32 v47, v47
    v_exp_f32 v48, v48
    v_exp_f32 v49, v49
    v_smfmac_f32_32x32x32_bf16 v[96:111], v[180:183], v[40:47], v8
    s_waitcnt lgkmcnt(2)
    v_exp_f32 v50, v50
    v_exp_f32 v51, v51
    v_exp_f32 v52, v52
    v_exp_f32 v53, v53
    v_exp_f32 v54, v54
    v_mfma_f32_32x32x16_bf16 v[16:31], v[160:163], v[144:147], 0
    v_exp_f32 v55, v55
    v_exp_f32 v56, v56
    v_exp_f32 v57, v57
    v_exp_f32 v58, v58
    v_smfmac_f32_32x32x32_bf16 v[112:127], v[176:179], v[48:55], v8
    s_sub_u32 s40, s40, 1
    v_exp_f32 v59, v59
    v_exp_f32 v60, v60
    v_exp_f32 v61, v61
    v_exp_f32 v62, v62
    v_exp_f32 v63, v63
    v_exp_f32 v64, v64
    v_exp_f32 v65, v65
    v_smfmac_f32_32x32x32_bf16 v[112:127], v[180:183], v[56:63], v8
    s_waitcnt lgkmcnt(0)
    v_exp_f32 v66, v66
    v_exp_f32 v67, v67
    v_exp_f32 v68, v68
    v_exp_f32 v69, v69
    v_exp_f32 v70, v70
    v_mfma_f32_32x32x16_bf16 v[32:47], v[160:163], v[148:151], 0
    v_exp_f32 v71, v71
    v_exp_f32 v72, v72
    v_exp_f32 v73, v73
    v_exp_f32 v74, v74
    v_smfmac_f32_32x32x32_bf16 v[128:143], v[176:179], v[64:71], v8
    s_cmp_lg_u32 s40, 0
    v_exp_f32 v75, v75
    v_exp_f32 v76, v76
    v_exp_f32 v77, v77
    v_exp_f32 v78, v78
    v_exp_f32 v79, v79
    s_cbranch_scc1 A_LOOP
    s_nop 0
    v_smfmac_f32_32x32x32_bf16 v[128:143], v[180:183], v[72:79], v8
    s_lshl_b32 s42, s17, 3
    s_lshl_b32 s43, s16, 1
    s_add_u32 s42, s42, s43
    s_lshl_b32 s42, s42, 16
    s_lshl_b32 s43, s18, 1
    s_add_u32 s43, s43, s33
    s_lshl_b32 s43, s43, 10
    s_add_u32 s42, s42, s43
    s_add_u32 s42, s42, 0x800000
    s_add_u32 s43, s42, 0x10000
    s_xor_b32 s44, s42, 0x20000
    s_xor_b32 s45, s43, 0x20000
    s_mov_b32 s46, 0x17800000
    s_mov_b32 s47, 0x67800000
    v_mov_b32 v2, 0
    v_mov_b32 v3, 0
    v_min3_f32 v4, v88, v104, v120
    v_max3_f32 v5, v88, v104, v120
    v_pk_fma_f32 v[2:3], v[80:81], 0, v[2:3]
    v_pk_fma_f32 v[2:3], v[82:83], 0, v[2:3]
    v_pk_fma_f32 v[2:3], v[84:85], 0, v[2:3]
    v_pk_fma_f32 v[2:3], v[86:87], 0, v[2:3]
    v_pk_fma_f32 v[2:3], v[96:97], 0, v[2:3]
    v_pk_fma_f32 v[2:3], v[98:99], 0, v[2:3]
    v_pk_fma_f32 v[2:3], v[100:101], 0, v[2:3]
    v_pk_fma_f32 v[2:3], v[102:103], 0, v[2:3]
    v_pk_fma_f32 v[2:3], v[112:113], 0, v[2:3]
    v_pk_fma_f32 v[2:3], v[114:115], 0, v[2:3]
    v_pk_fma_f32 v[2:3], v[116:117], 0, v[2:3]
    v_pk_fma_f32 v[2:3], v[118:119], 0, v[2:3]
    v_pk_fma_f32 v[2:3], v[128:129], 0, v[2:3]
    v_pk_fma_f32 v[2:3], v[130:131], 0, v[2:3]
    v_pk_fma_f32 v[2:3], v[132:133], 0, v[2:3]
    v_pk_fma_f32 v[2:3], v[134:135], 0, v[2:3]
    v_min_f32 v4, v4, v136
    v_max_f32 v5, v5, v136
    v_add_f32 v2, v2, v3
    v_cmp_lt_f32 s[48:49], s46, v4
    v_cmp_gt_f32 s[50:51], s47, v5
    v_cmp_eq_f32 vcc, 0, v2
    v_rcp_f32 v192, v88
    v_rcp_f32 v194, v104
    v_rcp_f32 v196, v120
    v_rcp_f32 v198, v136
    s_and_b64 s[48:49], s[48:49], s[50:51]
    s_and_b64 s[48:49], s[48:49], vcc
    s_cmp_eq_u64 s[48:49], -1
    s_cbranch_scc0 A_SLOW
    v_pk_mul_f32 v[80:81], v[80:81], v[192:193] op_sel_hi:[1,0]
    v_pk_mul_f32 v[82:83], v[82:83], v[192:193] op_sel_hi:[1,0]
    v_pk_mul_f32 v[84:85], v[84:85], v[192:193] op_sel_hi:[1,0]
    v_pk_mul_f32 v[86:87], v[86:87], v[192:193] op_sel_hi:[1,0]
    v_cvt_pk_bf16_f32 v16, v80, v81
    v_cvt_pk_bf16_f32 v17, v82, v83
    v_cvt_pk_bf16_f32 v18, v84, v85
    v_cvt_pk_bf16_f32 v19, v86, v87
    buffer_store_dwordx4 v[16:19], v15, s[28:31], s42 offen sc1
    v_pk_mul_f32 v[96:97], v[96:97], v[194:195] op_sel_hi:[1,0]
    v_pk_mul_f32 v[98:99], v[98:99], v[194:195] op_sel_hi:[1,0]
    v_pk_mul_f32 v[100:101], v[100:101], v[194:195] op_sel_hi:[1,0]
    v_pk_mul_f32 v[102:103], v[102:103], v[194:195] op_sel_hi:[1,0]
    v_cvt_pk_bf16_f32 v20, v96, v97
    v_cvt_pk_bf16_f32 v21, v98, v99
    v_cvt_pk_bf16_f32 v22, v100, v101
    v_cvt_pk_bf16_f32 v23, v102, v103
    buffer_store_dwordx4 v[20:23], v15, s[28:31], s43 offen sc1
    v_pk_mul_f32 v[112:113], v[112:113], v[196:197] op_sel_hi:[1,0]
    v_pk_mul_f32 v[114:115], v[114:115], v[196:197] op_sel_hi:[1,0]
    v_pk_mul_f32 v[116:117], v[116:117], v[196:197] op_sel_hi:[1,0]
    v_pk_mul_f32 v[118:119], v[118:119], v[196:197] op_sel_hi:[1,0]
    v_cvt_pk_bf16_f32 v24, v112, v113
    v_cvt_pk_bf16_f32 v25, v114, v115
    v_cvt_pk_bf16_f32 v26, v116, v117
    v_cvt_pk_bf16_f32 v27, v118, v119
    buffer_store_dwordx4 v[24:27], v15, s[28:31], s44 offen sc1
    v_pk_mul_f32 v[128:129], v[128:129], v[198:199] op_sel_hi:[1,0]
    v_pk_mul_f32 v[130:131], v[130:131], v[198:199] op_sel_hi:[1,0]
    v_pk_mul_f32 v[132:133], v[132:133], v[198:199] op_sel_hi:[1,0]
    v_pk_mul_f32 v[134:135], v[134:135], v[198:199] op_sel_hi:[1,0]
    v_cvt_pk_bf16_f32 v28, v128, v129
    v_cvt_pk_bf16_f32 v29, v130, v131
    v_cvt_pk_bf16_f32 v30, v132, v133
    v_cvt_pk_bf16_f32 v31, v134, v135
    buffer_store_dwordx4 v[28:31], v15, s[28:31], s45 offen sc1
A_DONE:
    s_barrier
K_END:
    s_endpgm
A_WAIT:
    s_sub_u32 s101, s101, 1
    s_cbranch_scc1 K_END
    ds_read_b32 v12, v11
    s_waitcnt lgkmcnt(0)
    v_cmp_gt_u32 vcc, s39, v12
    s_cbranch_vccnz A_WAIT
    s_branch A_BACK
A_SLOW:
    s_lshl_b32 s38, s18, 18
    s_mov_b32 s40, 64
    v_mov_b32 v184, 0xff800000
    v_mov_b32 v185, 0xff800000
    v_mov_b32 v186, 0xff800000
    v_mov_b32 v187, 0xff800000
A_MAXLOOP:
    buffer_load_dwordx4 v[160:163], v10, s[28:31], s38 offen sc1
    s_add_u32 s38, s38, 4096
    s_waitcnt vmcnt(0)
    v_mfma_f32_32x32x16_bf16 v[16:31], v[160:163], v[144:147], 0
    v_mfma_f32_32x32x16_bf16 v[32:47], v[160:163], v[148:151], 0
    v_mfma_f32_32x32x16_bf16 v[48:63], v[160:163], v[152:155], 0
    v_mfma_f32_32x32x16_bf16 v[64:79], v[160:163], v[156:159], 0
    s_nop 11
    v_max3_f32 v184, v184, v16, v17
    v_max3_f32 v184, v184, v18, v19
    v_max3_f32 v184, v184, v20, v21
    v_max3_f32 v184, v184, v22, v23
    v_max3_f32 v184, v184, v24, v25
    v_max3_f32 v184, v184, v26, v27
    v_max3_f32 v184, v184, v28, v29
    v_max3_f32 v184, v184, v30, v31
    v_max3_f32 v185, v185, v32, v33
    v_max3_f32 v185, v185, v34, v35
    v_max3_f32 v185, v185, v36, v37
    v_max3_f32 v185, v185, v38, v39
    v_max3_f32 v185, v185, v40, v41
    v_max3_f32 v185, v185, v42, v43
    v_max3_f32 v185, v185, v44, v45
    v_max3_f32 v185, v185, v46, v47
    v_max3_f32 v186, v186, v48, v49
    v_max3_f32 v186, v186, v50, v51
    v_max3_f32 v186, v186, v52, v53
    v_max3_f32 v186, v186, v54, v55
    v_max3_f32 v186, v186, v56, v57
    v_max3_f32 v186, v186, v58, v59
    v_max3_f32 v186, v186, v60, v61
    v_max3_f32 v186, v186, v62, v63
    v_max3_f32 v187, v187, v64, v65
    v_max3_f32 v187, v187, v66, v67
    v_max3_f32 v187, v187, v68, v69
    v_max3_f32 v187, v187, v70, v71
    v_max3_f32 v187, v187, v72, v73
    v_max3_f32 v187, v187, v74, v75
    v_max3_f32 v187, v187, v76, v77
    v_max3_f32 v187, v187, v78, v79
    s_sub_u32 s40, s40, 1
    s_cmp_lg_u32 s40, 0
    s_cbranch_scc1 A_MAXLOOP
    v_mov_b32 v188, v184
    v_mov_b32 v189, v185
    v_mov_b32 v190, v186
    v_mov_b32 v191, v187
    s_nop 1
    v_permlane32_swap_b32 v184, v188
    v_permlane32_swap_b32 v185, v189
    v_permlane32_swap_b32 v186, v190
    v_permlane32_swap_b32 v187, v191
    s_nop 1
    v_max_f32 v184, v184, v188
    v_max_f32 v185, v185, v189
    v_max_f32 v186, v186, v190
    v_max_f32 v187, v187, v191
    v_mov_b32 v80, 0
    v_mov_b32 v81, 0
    v_mov_b32 v82, 0
    v_mov_b32 v83, 0
    v_mov_b32 v84, 0
    v_mov_b32 v85, 0
    v_mov_b32 v86, 0
    v_mov_b32 v87, 0
    v_mov_b32 v88, 0
    v_mov_b32 v89, 0
    v_mov_b32 v90, 0
    v_mov_b32 v91, 0
    v_mov_b32 v92, 0
    v_mov_b32 v93, 0
    v_mov_b32 v94, 0
    v_mov_b32 v95, 0
    v_mov_b32 v96, 0
    v_mov_b32 v97, 0
    v_mov_b32 v98, 0
    v_mov_b32 v99, 0
    v_mov_b32 v100, 0
    v_mov_b32 v101, 0
    v_mov_b32 v102, 0
    v_mov_b32 v103, 0
    v_mov_b32 v104, 0
    v_mov_b32 v105, 0
    v_mov_b32 v106, 0
    v_mov_b32 v107, 0
    v_mov_b32 v108, 0
    v_mov_b32 v109, 0
    v_mov_b32 v110, 0
    v_mov_b32 v111, 0
    v_mov_b32 v112, 0
    v_mov_b32 v113, 0
    v_mov_b32 v114, 0
    v_mov_b32 v115, 0
    v_mov_b32 v116, 0
    v_mov_b32 v117, 0
    v_mov_b32 v118, 0
    v_mov_b32 v119, 0
    v_mov_b32 v120, 0
    v_mov_b32 v121, 0
    v_mov_b32 v122, 0
    v_mov_b32 v123, 0
    v_mov_b32 v124, 0
    v_mov_b32 v125, 0
    v_mov_b32 v126, 0
    v_mov_b32 v127, 0
    v_mov_b32 v128, 0
    v_mov_b32 v129, 0
    v_mov_b32 v130, 0
    v_mov_b32 v131, 0
    v_mov_b32 v132, 0
    v_mov_b32 v133, 0
    v_mov_b32 v134, 0
    v_mov_b32 v135, 0
    v_mov_b32 v136, 0
    v_mov_b32 v137, 0
    v_mov_b32 v138, 0
    v_mov_b32 v139, 0
    v_mov_b32 v140, 0
    v_mov_b32 v141, 0
    v_mov_b32 v142, 0
    v_mov_b32 v143, 0
    s_mov_b32 vcc_lo, 0x110000
    s_mov_b32 vcc_hi, 0x110000
    v_mov_b32 v12, 0x3f803f80
    v_cndmask_b32 v168, 0, v12, vcc
    v_cndmask_b32 v169, 0, v12, vcc
    v_cndmask_b32 v170, 0, v12, vcc
    v_cndmask_b32 v171, 0, v12, vcc
    v_cndmask_b32 v172, 0, v12, vcc
    v_cndmask_b32 v173, 0, v12, vcc
    v_cndmask_b32 v174, 0, v12, vcc
    v_cndmask_b32 v175, 0, v12, vcc
    s_lshl_b32 s38, s18, 18
    s_mov_b32 s40, 64
A_EXPLOOP:
    buffer_load_dwordx4 v[160:163], v10, s[28:31], s38 offen sc1
    s_mov_b64 exec, s[36:37]
    buffer_load_dwordx4 v[168:171], v10, s[28:31], s38 offen offset:1024 sc1
    buffer_load_dwordx4 v[172:175], v10, s[28:31], s38 offen offset:1280 sc1
    s_mov_b64 exec, -1
    s_add_u32 s38, s38, 4096
    s_waitcnt vmcnt(0)
    v_mfma_f32_32x32x16_bf16 v[16:31], v[160:163], v[144:147], 0
    v_mfma_f32_32x32x16_bf16 v[32:47], v[160:163], v[148:151], 0
    v_mfma_f32_32x32x16_bf16 v[48:63], v[160:163], v[152:155], 0
    v_mfma_f32_32x32x16_bf16 v[64:79], v[160:163], v[156:159], 0
    s_nop 11
    v_sub_f32 v16, v16, v184
    v_sub_f32 v17, v17, v184
    v_sub_f32 v18, v18, v184
    v_sub_f32 v19, v19, v184
    v_sub_f32 v20, v20, v184
    v_sub_f32 v21, v21, v184
    v_sub_f32 v22, v22, v184
    v_sub_f32 v23, v23, v184
    v_sub_f32 v24, v24, v184
    v_sub_f32 v25, v25, v184
    v_sub_f32 v26, v26, v184
    v_sub_f32 v27, v27, v184
    v_sub_f32 v28, v28, v184
    v_sub_f32 v29, v29, v184
    v_sub_f32 v30, v30, v184
    v_sub_f32 v31, v31, v184
    v_exp_f32 v16, v16
    v_exp_f32 v17, v17
    v_exp_f32 v18, v18
    v_exp_f32 v19, v19
    v_exp_f32 v20, v20
    v_exp_f32 v21, v21
    v_exp_f32 v22, v22
    v_exp_f32 v23, v23
    v_exp_f32 v24, v24
    v_exp_f32 v25, v25
    v_exp_f32 v26, v26
    v_exp_f32 v27, v27
    v_exp_f32 v28, v28
    v_exp_f32 v29, v29
    v_exp_f32 v30, v30
    v_exp_f32 v31, v31
    s_nop 1
    v_smfmac_f32_32x32x32_bf16 v[80:95], v[168:171], v[16:23], v8
    v_smfmac_f32_32x32x32_bf16 v[80:95], v[172:175], v[24:31], v8
    v_sub_f32 v32, v32, v185
    v_sub_f32 v33, v33, v185
    v_sub_f32 v34, v34, v185
    v_sub_f32 v35, v35, v185
    v_sub_f32 v36, v36, v185
    v_sub_f32 v37, v37, v185
    v_sub_f32 v38, v38, v185
    v_sub_f32 v39, v39, v185
    v_sub_f32 v40, v40, v185
    v_sub_f32 v41, v41, v185
    v_sub_f32 v42, v42, v185
    v_sub_f32 v43, v43, v185
    v_sub_f32 v44, v44, v185
    v_sub_f32 v45, v45, v185
    v_sub_f32 v46, v46, v185
    v_sub_f32 v47, v47, v185
    v_exp_f32 v32, v32
    v_exp_f32 v33, v33
    v_exp_f32 v34, v34
    v_exp_f32 v35, v35
    v_exp_f32 v36, v36
    v_exp_f32 v37, v37
    v_exp_f32 v38, v38
    v_exp_f32 v39, v39
    v_exp_f32 v40, v40
    v_exp_f32 v41, v41
    v_exp_f32 v42, v42
    v_exp_f32 v43, v43
    v_exp_f32 v44, v44
    v_exp_f32 v45, v45
    v_exp_f32 v46, v46
    v_exp_f32 v47, v47
    s_nop 1
    v_smfmac_f32_32x32x32_bf16 v[96:111], v[168:171], v[32:39], v8
    v_smfmac_f32_32x32x32_bf16 v[96:111], v[172:175], v[40:47], v8
    v_sub_f32 v48, v48, v186
    v_sub_f32 v49, v49, v186
    v_sub_f32 v50, v50, v186
    v_sub_f32 v51, v51, v186
    v_sub_f32 v52, v52, v186
    v_sub_f32 v53, v53, v186
    v_sub_f32 v54, v54, v186
    v_sub_f32 v55, v55, v186
    v_sub_f32 v56, v56, v186
    v_sub_f32 v57, v57, v186
    v_sub_f32 v58, v58, v186
    v_sub_f32 v59, v59, v186
    v_sub_f32 v60, v60, v186
    v_sub_f32 v61, v61, v186
    v_sub_f32 v62, v62, v186
    v_sub_f32 v63, v63, v186
    v_exp_f32 v48, v48
    v_exp_f32 v49, v49
    v_exp_f32 v50, v50
    v_exp_f32 v51, v51
    v_exp_f32 v52, v52
    v_exp_f32 v53, v53
    v_exp_f32 v54, v54
    v_exp_f32 v55, v55
    v_exp_f32 v56, v56
    v_exp_f32 v57, v57
    v_exp_f32 v58, v58
    v_exp_f32 v59, v59
    v_exp_f32 v60, v60
    v_exp_f32 v61, v61
    v_exp_f32 v62, v62
    v_exp_f32 v63, v63
    s_nop 1
    v_smfmac_f32_32x32x32_bf16 v[112:127], v[168:171], v[48:55], v8
    v_smfmac_f32_32x32x32_bf16 v[112:127], v[172:175], v[56:63], v8
    v_sub_f32 v64, v64, v187
    v_sub_f32 v65, v65, v187
    v_sub_f32 v66, v66, v187
    v_sub_f32 v67, v67, v187
    v_sub_f32 v68, v68, v187
    v_sub_f32 v69, v69, v187
    v_sub_f32 v70, v70, v187
    v_sub_f32 v71, v71, v187
    v_sub_f32 v72, v72, v187
    v_sub_f32 v73, v73, v187
    v_sub_f32 v74, v74, v187
    v_sub_f32 v75, v75, v187
    v_sub_f32 v76, v76, v187
    v_sub_f32 v77, v77, v187
    v_sub_f32 v78, v78, v187
    v_sub_f32 v79, v79, v187
    v_exp_f32 v64, v64
    v_exp_f32 v65, v65
    v_exp_f32 v66, v66
    v_exp_f32 v67, v67
    v_exp_f32 v68, v68
    v_exp_f32 v69, v69
    v_exp_f32 v70, v70
    v_exp_f32 v71, v71
    v_exp_f32 v72, v72
    v_exp_f32 v73, v73
    v_exp_f32 v74, v74
    v_exp_f32 v75, v75
    v_exp_f32 v76, v76
    v_exp_f32 v77, v77
    v_exp_f32 v78, v78
    v_exp_f32 v79, v79
    s_nop 1
    v_smfmac_f32_32x32x32_bf16 v[128:143], v[168:171], v[64:71], v8
    v_smfmac_f32_32x32x32_bf16 v[128:143], v[172:175], v[72:79], v8
    s_sub_u32 s40, s40, 1
    s_cmp_lg_u32 s40, 0
    s_cbranch_scc1 A_EXPLOOP
    s_nop 11
    v_rcp_f32 v192, v88
    v_rcp_f32 v194, v104
    v_rcp_f32 v196, v120
    v_rcp_f32 v198, v136
    s_nop 0
    v_pk_mul_f32 v[80:81], v[80:81], v[192:193] op_sel_hi:[1,0]
    v_pk_mul_f32 v[82:83], v[82:83], v[192:193] op_sel_hi:[1,0]
    v_pk_mul_f32 v[84:85], v[84:85], v[192:193] op_sel_hi:[1,0]
    v_pk_mul_f32 v[86:87], v[86:87], v[192:193] op_sel_hi:[1,0]
    v_cvt_pk_bf16_f32 v16, v80, v81
    v_cvt_pk_bf16_f32 v17, v82, v83
    v_cvt_pk_bf16_f32 v18, v84, v85
    v_cvt_pk_bf16_f32 v19, v86, v87
    v_min_u32 v16, -2, v16
    v_min_u32 v17, -2, v17
    v_min_u32 v18, -2, v18
    v_min_u32 v19, -2, v19
    buffer_store_dwordx4 v[16:19], v15, s[28:31], s42 offen sc1
    v_pk_mul_f32 v[96:97], v[96:97], v[194:195] op_sel_hi:[1,0]
    v_pk_mul_f32 v[98:99], v[98:99], v[194:195] op_sel_hi:[1,0]
    v_pk_mul_f32 v[100:101], v[100:101], v[194:195] op_sel_hi:[1,0]
    v_pk_mul_f32 v[102:103], v[102:103], v[194:195] op_sel_hi:[1,0]
    v_cvt_pk_bf16_f32 v20, v96, v97
    v_cvt_pk_bf16_f32 v21, v98, v99
    v_cvt_pk_bf16_f32 v22, v100, v101
    v_cvt_pk_bf16_f32 v23, v102, v103
    v_min_u32 v20, -2, v20
    v_min_u32 v21, -2, v21
    v_min_u32 v22, -2, v22
    v_min_u32 v23, -2, v23
    buffer_store_dwordx4 v[20:23], v15, s[28:31], s43 offen sc1
    v_pk_mul_f32 v[112:113], v[112:113], v[196:197] op_sel_hi:[1,0]
    v_pk_mul_f32 v[114:115], v[114:115], v[196:197] op_sel_hi:[1,0]
    v_pk_mul_f32 v[116:117], v[116:117], v[196:197] op_sel_hi:[1,0]
    v_pk_mul_f32 v[118:119], v[118:119], v[196:197] op_sel_hi:[1,0]
    v_cvt_pk_bf16_f32 v24, v112, v113
    v_cvt_pk_bf16_f32 v25, v114, v115
    v_cvt_pk_bf16_f32 v26, v116, v117
    v_cvt_pk_bf16_f32 v27, v118, v119
    v_min_u32 v24, -2, v24
    v_min_u32 v25, -2, v25
    v_min_u32 v26, -2, v26
    v_min_u32 v27, -2, v27
    buffer_store_dwordx4 v[24:27], v15, s[28:31], s44 offen sc1
    v_pk_mul_f32 v[128:129], v[128:129], v[198:199] op_sel_hi:[1,0]
    v_pk_mul_f32 v[130:131], v[130:131], v[198:199] op_sel_hi:[1,0]
    v_pk_mul_f32 v[132:133], v[132:133], v[198:199] op_sel_hi:[1,0]
    v_pk_mul_f32 v[134:135], v[134:135], v[198:199] op_sel_hi:[1,0]
    v_cvt_pk_bf16_f32 v28, v128, v129
    v_cvt_pk_bf16_f32 v29, v130, v131
    v_cvt_pk_bf16_f32 v30, v132, v133
    v_cvt_pk_bf16_f32 v31, v134, v135
    v_min_u32 v28, -2, v28
    v_min_u32 v29, -2, v29
    v_min_u32 v30, -2, v30
    v_min_u32 v31, -2, v31
    buffer_store_dwordx4 v[28:31], v15, s[28:31], s45 offen sc1
    s_branch A_DONE
HELPER:
    s_sub_u32 s16, s16, 4
    s_cmp_ge_u32 s18, 16
    s_waitcnt lgkmcnt(0)
    s_cselect_b32 s24, s14, s24
    s_cselect_b32 s25, s15, s25
    s_mov_b32 s30, 0xd00000
    s_mov_b32 s31, s23
    s_mov_b32 s101, 0x100000
    s_lshl_b32 s8, s16, 5
    s_mov_b32 s14, 256
    s_mov_b32 s15, s23
    s_add_u32 s10, s10, s8
    s_addc_u32 s11, s11, 0
    v_mov_b32 v11, 0
    s_or_b32 s32, s2, s16
    s_cmp_lg_u32 s32, 0
    s_cbranch_scc1 H_NOTAG
    s_memrealtime s[32:33]
    s_waitcnt lgkmcnt(0)
    s_or_b32 s32, s32, 1
    v_mov_b32 v2, s32
    v_mov_b32 v3, s33
    s_mov_b64 exec, 1
    buffer_store_dwordx2 v[2:3], v11, s[12:15], 0 offen sc1
    s_mov_b64 exec, -1
H_NOTAG:
    s_add_u32 s8, s9, 0
    s_and_b32 s8, s8, 7
    s_lshl_b32 s8, s8, 7
    s_load_dwordx8 s[32:39], s[10:11], s8
    s_add_u32 s8, s9, 1
    s_and_b32 s8, s8, 7
    s_lshl_b32 s8, s8, 7
    s_load_dwordx8 s[40:47], s[10:11], s8
    s_add_u32 s8, s9, 2
    s_and_b32 s8, s8, 7
    s_lshl_b32 s8, s8, 7
    s_load_dwordx8 s[48:55], s[10:11], s8
    s_add_u32 s8, s9, 3
    s_and_b32 s8, s8, 7
    s_lshl_b32 s8, s8, 7
    s_load_dwordx8 s[56:63], s[10:11], s8
    s_add_u32 s8, s9, 4
    s_and_b32 s8, s8, 7
    s_lshl_b32 s8, s8, 7
    s_load_dwordx8 s[64:71], s[10:11], s8
    s_add_u32 s8, s9, 5
    s_and_b32 s8, s8, 7
    s_lshl_b32 s8, s8, 7
    s_load_dwordx8 s[72:79], s[10:11], s8
    s_add_u32 s8, s9, 6
    s_and_b32 s8, s8, 7
    s_lshl_b32 s8, s8, 7
    s_load_dwordx8 s[80:87], s[10:11], s8
    s_add_u32 s8, s9, 7
    s_and_b32 s8, s8, 7
    s_lshl_b32 s8, s8, 7
    s_load_dwordx8 s[88:95], s[10:11], s8
    s_lshl_b32 s7, s16, 8
    s_add_u32 s8, s7, 156672
    v_lshlrev_b32 v37, 2, v0
    v_add_u32 v44, s8, v37
    v_mov_b32 v32, 0
    ds_write_b32 v44, v32
    s_add_u32 s8, s7, 155648
    v_add_u32 v37, s8, v37
    v_bfe_u32 v1, v0, 1, 3
    s_lshl_b32 s8, s16, 1
    v_xor_b32 v1, s8, v1
    v_lshlrev_b32 v1, 4, v1
    v_lshl_add_u32 v1, v0, 7, v1
    s_lshl_b32 s8, s19, 13
    v_add_u32 v33, s8, v1
    v_xor_b32 v34, 16, v33
    v_add_u32 v35, 90112, v33
    v_add_u32 v36, 90112, v34
    v_and_b32 v14, 3, v0
    v_lshlrev_b32 v14, 8, v14
    v_add_u32 v14, 157696, v14
    s_add_u32 s8, s9, 1
    s_and_b32 s8, s8, 7
    s_mul_i32 s100, s8, 196608
    s_add_u32 s100, s100, s5
    s_lshl_b32 s8, s8, 7
    s_add_u32 s8, s8, s4
    s_barrier
    s_add_u32 m0, s6, 81920
    s_add_u32 s7, s100, 1024
    buffer_load_dwordx4 v5, s[24:27], s7 offen lds
    s_add_u32 m0, s6, 45056
    s_add_u32 s7, s8, 0
    buffer_load_dwordx4 v4, s[20:23], s7 offen lds
    s_add_u32 m0, s6, 86016
    s_add_u32 s7, s100, 2048
    buffer_load_dwordx4 v5, s[24:27], s7 offen lds
    s_add_u32 m0, s6, 49152
    s_add_u32 s7, s8, 32768
    buffer_load_dwordx4 v4, s[20:23], s7 offen lds
    s_add_u32 m0, s6, 77824
    s_add_u32 s7, s100, 0
    buffer_load_dwordx4 v5, s[24:27], s7 offen lds
    s_add_u32 m0, s6, 53248
    s_add_u32 s7, s8, 65536
    buffer_load_dwordx4 v4, s[20:23], s7 offen lds
    s_add_u32 m0, s6, 57344
    s_add_u32 s7, s8, 98304
    buffer_load_dwordx4 v4, s[20:23], s7 offen lds
    s_add_u32 m0, s6, 61440
    s_add_u32 s7, s8, 131072
    buffer_load_dwordx4 v4, s[20:23], s7 offen lds
    s_add_u32 m0, s6, 65536
    s_add_u32 s7, s8, 163840
    buffer_load_dwordx4 v4, s[20:23], s7 offen lds
    s_add_u32 m0, s6, 69632
    s_add_u32 s7, s8, 196608
    buffer_load_dwordx4 v4, s[20:23], s7 offen lds
    s_add_u32 m0, s6, 73728
    s_add_u32 s7, s8, 229376
    buffer_load_dwordx4 v4, s[20:23], s7 offen lds
H_LAND:
    s_sub_u32 s101, s101, 1
    s_cbranch_scc1 K_END
    ds_read_b32 v22, v14
    s_waitcnt lgkmcnt(0)
    v_cmp_eq_u32 vcc, 0, v22
    s_cbranch_vccnz H_LAND
    ds_read_b128 v[16:19], v33 offset:0
    ds_read_b128 v[20:23], v34 offset:0
    s_waitcnt lgkmcnt(0)
    v_dot2_f32_bf16 v32, v16, s32, v32
    v_dot2_f32_bf16 v32, v17, s33, v32
    v_dot2_f32_bf16 v32, v18, s34, v32
    v_dot2_f32_bf16 v32, v19, s35, v32
    v_dot2_f32_bf16 v32, v20, s36, v32
    v_dot2_f32_bf16 v32, v21, s37, v32
    v_dot2_f32_bf16 v32, v22, s38, v32
    v_dot2_f32_bf16 v32, v23, s39, v32
    s_add_u32 s8, s9, 2
    s_and_b32 s8, s8, 7
    s_mul_i32 s100, s8, 196608
    s_add_u32 s100, s100, s5
    s_lshl_b32 s8, s8, 7
    s_add_u32 s8, s8, s4
    s_add_u32 m0, s6, 126976
    s_add_u32 s7, s100, 1024
    buffer_load_dwordx4 v5, s[24:27], s7 offen lds
    s_add_u32 m0, s6, 90112
    s_add_u32 s7, s8, 0
    buffer_load_dwordx4 v4, s[20:23], s7 offen lds
    s_add_u32 m0, s6, 131072
    s_add_u32 s7, s100, 2048
    buffer_load_dwordx4 v5, s[24:27], s7 offen lds
    s_add_u32 m0, s6, 94208
    s_add_u32 s7, s8, 32768
    buffer_load_dwordx4 v4, s[20:23], s7 offen lds
    s_add_u32 m0, s6, 122880
    s_add_u32 s7, s100, 0
    buffer_load_dwordx4 v5, s[24:27], s7 offen lds
    s_add_u32 m0, s6, 98304
    s_add_u32 s7, s8, 65536
    buffer_load_dwordx4 v4, s[20:23], s7 offen lds
    s_add_u32 m0, s6, 102400
    s_add_u32 s7, s8, 98304
    buffer_load_dwordx4 v4, s[20:23], s7 offen lds
    s_add_u32 m0, s6, 106496
    s_add_u32 s7, s8, 131072
    buffer_load_dwordx4 v4, s[20:23], s7 offen lds
    s_add_u32 m0, s6, 110592
    s_add_u32 s7, s8, 163840
    buffer_load_dwordx4 v4, s[20:23], s7 offen lds
    s_add_u32 m0, s6, 114688
    s_add_u32 s7, s8, 196608
    buffer_load_dwordx4 v4, s[20:23], s7 offen lds
    s_add_u32 m0, s6, 118784
    s_add_u32 s7, s8, 229376
    buffer_load_dwordx4 v4, s[20:23], s7 offen lds
    s_waitcnt vmcnt(11)
    s_barrier
    s_add_u32 s8, s9, 3
    s_and_b32 s8, s8, 7
    s_mul_i32 s100, s8, 196608
    s_add_u32 s100, s100, s5
    s_lshl_b32 s8, s8, 7
    s_add_u32 s8, s8, s4
    s_add_u32 m0, s6, 36864
    s_add_u32 s7, s100, 1024
    buffer_load_dwordx4 v5, s[24:27], s7 offen lds
    s_add_u32 m0, s6, 0
    s_add_u32 s7, s8, 0
    buffer_load_dwordx4 v4, s[20:23], s7 offen lds
    s_add_u32 m0, s6, 40960
    s_add_u32 s7, s100, 2048
    buffer_load_dwordx4 v5, s[24:27], s7 offen lds
    s_add_u32 m0, s6, 4096
    s_add_u32 s7, s8, 32768
    buffer_load_dwordx4 v4, s[20:23], s7 offen lds
    s_add_u32 m0, s6, 32768
    s_add_u32 s7, s100, 0
    buffer_load_dwordx4 v5, s[24:27], s7 offen lds
    s_add_u32 m0, s6, 8192
    s_add_u32 s7, s8, 65536
    buffer_load_dwordx4 v4, s[20:23], s7 offen lds
    s_add_u32 m0, s6, 12288
    s_add_u32 s7, s8, 98304
    buffer_load_dwordx4 v4, s[20:23], s7 offen lds
    s_add_u32 m0, s6, 16384
    s_add_u32 s7, s8, 131072
    buffer_load_dwordx4 v4, s[20:23], s7 offen lds
    s_add_u32 m0, s6, 20480
    s_add_u32 s7, s8, 163840
    buffer_load_dwordx4 v4, s[20:23], s7 offen lds
    s_add_u32 m0, s6, 24576
    s_add_u32 s7, s8, 196608
    buffer_load_dwordx4 v4, s[20:23], s7 offen lds
    s_add_u32 m0, s6, 28672
    s_add_u32 s7, s8, 229376
    buffer_load_dwordx4 v4, s[20:23], s7 offen lds
    ds_read_b128 v[16:19], v33 offset:45056
    ds_read_b128 v[20:23], v34 offset:45056
    v_lshrrev_b32 v7, 5, v0
    v_and_b32 v6, 31, v0
    v_lshlrev_b32 v10, 10, v6
    v_lshl_add_u32 v10, v7, 6, v10
    s_and_b32 s7, s16, 1
    s_lshl_b32 s7, s7, 7
    s_add_u32 s7, s7, 155648
    v_lshl_add_u32 v49, v6, 2, s7
    v_lshrrev_b32 v46, 3, v0
    v_and_b32 v6, 7, v0
    v_bfe_u32 v8, v0, 4, 1
    v_lshlrev_b32 v9, 1, v8
    v_xor_b32 v6, v9, v6
    v_lshlrev_b32 v6, 4, v6
    v_lshl_add_u32 v46, v46, 10, v6
    s_waitcnt lgkmcnt(0)
    v_dot2_f32_bf16 v32, v16, s40, v32
    v_dot2_f32_bf16 v32, v17, s41, v32
    v_dot2_f32_bf16 v32, v18, s42, v32
    v_dot2_f32_bf16 v32, v19, s43, v32
    v_dot2_f32_bf16 v32, v20, s44, v32
    v_dot2_f32_bf16 v32, v21, s45, v32
    v_dot2_f32_bf16 v32, v22, s46, v32
    v_dot2_f32_bf16 v32, v23, s47, v32
    s_waitcnt vmcnt(11)
    s_barrier
    s_add_u32 s8, s9, 4
    s_and_b32 s8, s8, 7
    s_mul_i32 s100, s8, 196608
    s_add_u32 s100, s100, s5
    s_lshl_b32 s8, s8, 7
    s_add_u32 s8, s8, s4
    s_add_u32 m0, s6, 81920
    s_add_u32 s7, s100, 1024
    buffer_load_dwordx4 v5, s[24:27], s7 offen lds
    s_add_u32 m0, s6, 45056
    s_add_u32 s7, s8, 0
    buffer_load_dwordx4 v4, s[20:23], s7 offen lds
    s_add_u32 m0, s6, 86016
    s_add_u32 s7, s100, 2048
    buffer_load_dwordx4 v5, s[24:27], s7 offen lds
    s_add_u32 m0, s6, 49152
    s_add_u32 s7, s8, 32768
    buffer_load_dwordx4 v4, s[20:23], s7 offen lds
    s_add_u32 m0, s6, 77824
    s_add_u32 s7, s100, 0
    buffer_load_dwordx4 v5, s[24:27], s7 offen lds
    s_add_u32 m0, s6, 53248
    s_add_u32 s7, s8, 65536
    buffer_load_dwordx4 v4, s[20:23], s7 offen lds
    s_add_u32 m0, s6, 57344
    s_add_u32 s7, s8, 98304
    buffer_load_dwordx4 v4, s[20:23], s7 offen lds
    s_add_u32 m0, s6, 61440
    s_add_u32 s7, s8, 131072
    buffer_load_dwordx4 v4, s[20:23], s7 offen lds
    s_add_u32 m0, s6, 65536
    s_add_u32 s7, s8, 163840
    buffer_load_dwordx4 v4, s[20:23], s7 offen lds
    s_add_u32 m0, s6, 69632
    s_add_u32 s7, s8, 196608
    buffer_load_dwordx4 v4, s[20:23], s7 offen lds
    s_add_u32 m0, s6, 73728
    s_add_u32 s7, s8, 229376
    buffer_load_dwordx4 v4, s[20:23], s7 offen lds
    ds_read_b128 v[16:19], v35 offset:0
    ds_read_b128 v[20:23], v36 offset:0
    v_bfe_u32 v6, v0, 2, 2
    v_lshl_add_u32 v7, v7, 3, v6
    v_lshlrev_b32 v7, 7, v7
    v_lshl_add_u32 v7, v8, 4, v7
    v_and_b32 v8, 1, v0
    v_lshl_add_u32 v7, v8, 6, v7
    v_bfe_u32 v8, v0, 1, 1
    v_lshl_add_u32 v7, v8, 3, v7
    v_lshrrev_b32 v6, 1, v6
    v_lshl_add_u32 v7, v6, 5, v7
    s_lshl_b32 s7, s16, 4
    s_andn2_b32 s7, 32, s7
    v_xor_b32 v7, s7, v7
    s_waitcnt lgkmcnt(0)
    v_dot2_f32_bf16 v32, v16, s48, v32
    v_dot2_f32_bf16 v32, v17, s49, v32
    v_dot2_f32_bf16 v32, v18, s50, v32
    v_dot2_f32_bf16 v32, v19, s51, v32
    v_dot2_f32_bf16 v32, v20, s52, v32
    v_dot2_f32_bf16 v32, v21, s53, v32
    v_dot2_f32_bf16 v32, v22, s54, v32
    v_dot2_f32_bf16 v32, v23, s55, v32
    s_waitcnt vmcnt(11)
    s_barrier
    s_add_u32 s8, s9, 5
    s_and_b32 s8, s8, 7
    s_mul_i32 s100, s8, 196608
    s_add_u32 s100, s100, s5
    s_lshl_b32 s8, s8, 7
    s_add_u32 s8, s8, s4
    s_add_u32 m0, s6, 126976
    s_add_u32 s7, s100, 1024
    buffer_load_dwordx4 v5, s[24:27], s7 offen lds
    s_add_u32 m0, s6, 90112
    s_add_u32 s7, s8, 0
    buffer_load_dwordx4 v4, s[20:23], s7 offen lds
    s_add_u32 m0, s6, 131072
    s_add_u32 s7, s100, 2048
    buffer_load_dwordx4 v5, s[24:27], s7 offen lds
    s_add_u32 m0, s6, 94208
    s_add_u32 s7, s8, 32768
    buffer_load_dwordx4 v4, s[20:23], s7 offen lds
    s_add_u32 m0, s6, 122880
    s_add_u32 s7, s100, 0
    buffer_load_dwordx4 v5, s[24:27], s7 offen lds
    s_add_u32 m0, s6, 98304
    s_add_u32 s7, s8, 65536
    buffer_load_dwordx4 v4, s[20:23], s7 offen lds
    s_add_u32 m0, s6, 102400
    s_add_u32 s7, s8, 98304
    buffer_load_dwordx4 v4, s[20:23], s7 offen lds
    s_add_u32 m0, s6, 106496
    s_add_u32 s7, s8, 131072
    buffer_load_dwordx4 v4, s[20:23], s7 offen lds
    s_add_u32 m0, s6, 110592
    s_add_u32 s7, s8, 163840
    buffer_load_dwordx4 v4, s[20:23], s7 offen lds
    s_add_u32 m0, s6, 114688
    s_add_u32 s7, s8, 196608
    buffer_load_dwordx4 v4, s[20:23], s7 offen lds
    s_add_u32 m0, s6, 118784
    s_add_u32 s7, s8, 229376
    buffer_load_dwordx4 v4, s[20:23], s7 offen lds
    ds_read_b128 v[16:19], v33 offset:0
    ds_read_b128 v[20:23], v34 offset:0
    s_mul_i32 s7, s16, 6144
    s_add_u32 s7, s7, 131584
    v_add_u32 v47, s7, v7
    v_xor_b32 v48, 32, v47
    s_lshr_b32 s7, s16, 1
    s_mul_i32 s7, s7, 12288
    s_add_u32 s7, s7, 131584
    v_lshrrev_b32 v12, 5, v0
    v_mul_u32_u24 v12, 5120, v12
    v_add3_u32 v12, v12, v7, s7
    v_xor_b32 v15, 32, v12
    s_lshr_b32 s7, s16, 1
    s_lshl_b32 s7, s7, 14
    v_add_u32 v8, s7, v7
    v_xor_b32 v9, 32, v8
    v_add_u32 v6, 0x10000, v8
    v_add_u32 v7, 0x10000, v9
    s_waitcnt lgkmcnt(0)
    v_dot2_f32_bf16 v32, v16, s56, v32
    v_dot2_f32_bf16 v32, v17, s57, v32
    v_dot2_f32_bf16 v32, v18, s58, v32
    v_dot2_f32_bf16 v32, v19, s59, v32
    v_dot2_f32_bf16 v32, v20, s60, v32
    v_dot2_f32_bf16 v32, v21, s61, v32
    v_dot2_f32_bf16 v32, v22, s62, v32
    v_dot2_f32_bf16 v32, v23, s63, v32
    s_waitcnt vmcnt(11)
    s_barrier
    s_add_u32 s8, s9, 6
    s_and_b32 s8, s8, 7
    s_mul_i32 s100, s8, 196608
    s_add_u32 s100, s100, s5
    s_lshl_b32 s8, s8, 7
    s_add_u32 s8, s8, s4
    s_add_u32 m0, s6, 36864
    s_add_u32 s7, s100, 1024
    buffer_load_dwordx4 v5, s[24:27], s7 offen lds
    s_add_u32 m0, s6, 0
    s_add_u32 s7, s8, 0
    buffer_load_dwordx4 v4, s[20:23], s7 offen lds
    s_add_u32 m0, s6, 40960
    s_add_u32 s7, s100, 2048
    buffer_load_dwordx4 v5, s[24:27], s7 offen lds
    s_add_u32 m0, s6, 4096
    s_add_u32 s7, s8, 32768
    buffer_load_dwordx4 v4, s[20:23], s7 offen lds
    s_add_u32 m0, s6, 32768
    s_add_u32 s7, s100, 0
    buffer_load_dwordx4 v5, s[24:27], s7 offen lds
    s_add_u32 m0, s6, 8192
    s_add_u32 s7, s8, 65536
    buffer_load_dwordx4 v4, s[20:23], s7 offen lds
    s_add_u32 m0, s6, 12288
    s_add_u32 s7, s8, 98304
    buffer_load_dwordx4 v4, s[20:23], s7 offen lds
    s_add_u32 m0, s6, 16384
    s_add_u32 s7, s8, 131072
    buffer_load_dwordx4 v4, s[20:23], s7 offen lds
    s_add_u32 m0, s6, 20480
    s_add_u32 s7, s8, 163840
    buffer_load_dwordx4 v4, s[20:23], s7 offen lds
    s_add_u32 m0, s6, 24576
    s_add_u32 s7, s8, 196608
    buffer_load_dwordx4 v4, s[20:23], s7 offen lds
    s_add_u32 m0, s6, 28672
    s_add_u32 s7, s8, 229376
    buffer_load_dwordx4 v4, s[20:23], s7 offen lds
    ds_read_b128 v[16:19], v33 offset:45056
    ds_read_b128 v[20:23], v34 offset:45056
    v_lshlrev_b32 v1, 4, v0
    s_mul_i32 s7, s16, 8224
    v_add_u32 v39, s7, v1
    v_lshlrev_b32 v38, 7, v0
    v_mov_b32 v40, -1
    v_mov_b32 v41, -1
    v_mov_b32 v42, -1
    v_mov_b32 v43, -1
    v_mov_b32 v45, 1
    v_mov_b32 v51, 158720
    s_waitcnt lgkmcnt(0)
    v_dot2_f32_bf16 v32, v16, s64, v32
    v_dot2_f32_bf16 v32, v17, s65, v32
    v_dot2_f32_bf16 v32, v18, s66, v32
    v_dot2_f32_bf16 v32, v19, s67, v32
    v_dot2_f32_bf16 v32, v20, s68, v32
    v_dot2_f32_bf16 v32, v21, s69, v32
    v_dot2_f32_bf16 v32, v22, s70, v32
    v_dot2_f32_bf16 v32, v23, s71, v32
    s_waitcnt vmcnt(11)
    s_barrier
    s_add_u32 s8, s9, 7
    s_and_b32 s8, s8, 7
    s_mul_i32 s100, s8, 196608
    s_add_u32 s100, s100, s5
    s_lshl_b32 s8, s8, 7
    s_add_u32 s8, s8, s4
    s_add_u32 m0, s6, 81920
    s_add_u32 s7, s100, 1024
    buffer_load_dwordx4 v5, s[24:27], s7 offen lds
    s_add_u32 m0, s6, 45056
    s_add_u32 s7, s8, 0
    buffer_load_dwordx4 v4, s[20:23], s7 offen lds
    s_add_u32 m0, s6, 86016
    s_add_u32 s7, s100, 2048
    buffer_load_dwordx4 v5, s[24:27], s7 offen lds
    s_add_u32 m0, s6, 49152
    s_add_u32 s7, s8, 32768
    buffer_load_dwordx4 v4, s[20:23], s7 offen lds
    s_add_u32 m0, s6, 77824
    s_add_u32 s7, s100, 0
    buffer_load_dwordx4 v5, s[24:27], s7 offen lds
    s_add_u32 m0, s6, 53248
    s_add_u32 s7, s8, 65536
    buffer_load_dwordx4 v4, s[20:23], s7 offen lds
    s_add_u32 m0, s6, 57344
    s_add_u32 s7, s8, 98304
    buffer_load_dwordx4 v4, s[20:23], s7 offen lds
    s_add_u32 m0, s6, 61440
    s_add_u32 s7, s8, 131072
    buffer_load_dwordx4 v4, s[20:23], s7 offen lds
    s_add_u32 m0, s6, 65536
    s_add_u32 s7, s8, 163840
    buffer_load_dwordx4 v4, s[20:23], s7 offen lds
    s_add_u32 m0, s6, 69632
    s_add_u32 s7, s8, 196608
    buffer_load_dwordx4 v4, s[20:23], s7 offen lds
    s_add_u32 m0, s6, 73728
    s_add_u32 s7, s8, 229376
    buffer_load_dwordx4 v4, s[20:23], s7 offen lds
    buffer_load_dwordx2 v[2:3], v11, s[12:15], 0 offen sc1
    ds_read_b128 v[16:19], v35 offset:0
    ds_read_b128 v[20:23], v36 offset:0
    v_mul_u32_u24 v50, 4112, v0
    v_add_u32 v50, 36992, v50
    v_cmp_gt_u32 vcc, 24, v0
    v_mov_b32 v52, 0x30000
    v_mov_b32 v53, 0x3f803f80
    v_cndmask_b32 v50, v52, v50, vcc
    v_mov_b32 v52, v53
    v_mov_b32 v54, v53
    v_mov_b32 v55, v53
    s_waitcnt lgkmcnt(0)
    v_dot2_f32_bf16 v32, v16, s72, v32
    v_dot2_f32_bf16 v32, v17, s73, v32
    v_dot2_f32_bf16 v32, v18, s74, v32
    v_dot2_f32_bf16 v32, v19, s75, v32
    v_dot2_f32_bf16 v32, v20, s76, v32
    v_dot2_f32_bf16 v32, v21, s77, v32
    v_dot2_f32_bf16 v32, v22, s78, v32
    v_dot2_f32_bf16 v32, v23, s79, v32
    s_waitcnt vmcnt(12)
    s_barrier
    ds_read_b128 v[16:19], v33 offset:0
    ds_read_b128 v[20:23], v34 offset:0
    s_lshl_b32 s7, s16, 12
    s_add_u32 s7, s7, 98304
    v_add_u32 v4, s7, v1
    v_xor_b32 v5, 0x2000, v4
    s_waitcnt lgkmcnt(0)
    v_dot2_f32_bf16 v32, v16, s80, v32
    v_dot2_f32_bf16 v32, v17, s81, v32
    v_dot2_f32_bf16 v32, v18, s82, v32
    v_dot2_f32_bf16 v32, v19, s83, v32
    v_dot2_f32_bf16 v32, v20, s84, v32
    v_dot2_f32_bf16 v32, v21, s85, v32
    v_dot2_f32_bf16 v32, v22, s86, v32
    v_dot2_f32_bf16 v32, v23, s87, v32
    s_waitcnt vmcnt(1)
    s_barrier
    ds_read_b128 v[16:19], v33 offset:45056
    ds_read_b128 v[20:23], v34 offset:45056
    s_waitcnt lgkmcnt(0)
    v_dot2_f32_bf16 v32, v16, s88, v32
    v_dot2_f32_bf16 v32, v17, s89, v32
    v_dot2_f32_bf16 v32, v18, s90, v32
    v_dot2_f32_bf16 v32, v19, s91, v32
    v_dot2_f32_bf16 v32, v20, s92, v32
    v_dot2_f32_bf16 v32, v21, s93, v32
    v_dot2_f32_bf16 v32, v22, s94, v32
    v_dot2_f32_bf16 v32, v23, s95, v32
    s_load_dwordx2 s[4:5], s[0:1], 16
    s_load_dwordx2 s[6:7], s[0:1], 40
    s_load_dwordx2 s[8:9], s[0:1], 56
    s_nop 0
    ds_write_b32 v37, v32
H_TAG:
    s_waitcnt vmcnt(0)
    v_readfirstlane_b32 s32, v2
    v_readfirstlane_b32 s33, v3
    s_cmp_lg_u32 s32, 0
    s_cbranch_scc1 H_TAGOK
    s_sub_u32 s101, s101, 1
    s_cbranch_scc1 K_END
    buffer_load_dwordx2 v[2:3], v11, s[12:15], 0 offen sc1
    s_branch H_TAG
H_TAGOK:
    s_lshr_b32 s34, s16, 1
    s_and_b32 s35, s16, 1
    s_cmp_eq_u32 s34, 1
    s_waitcnt lgkmcnt(0)
    s_cselect_b32 s4, s6, s4
    s_cselect_b32 s5, s7, s5
    s_mov_b32 s20, s4
    s_mov_b32 s21, s5
    s_mov_b32 s22, 0x80000
    s_mov_b32 s23, 0x00020000
    s_mov_b32 s24, s8
    s_mov_b32 s25, s9
    s_mov_b32 s26, 0x200000
    s_mov_b32 s27, 0x00020000
    s_lshl_b32 s36, s16, 13
    s_lshl_b32 s37, s18, 18
    s_add_u32 s37, s37, s36
    s_lshl_b32 s38, s17, 15
    s_add_u32 s38, s38, s37
    s_add_u32 s39, s38, 4096
    s_mul_i32 s36, s16, 8224
    s_lshl_b32 s40, s18, 12
    s_lshl_b32 s41, s16, 7
    s_add_u32 s40, s40, s41
    s_add_u32 s40, s40, 0xc00000
    ds_write_b64 v51, v[2:3]
    s_waitcnt lgkmcnt(0)
    s_barrier
    ds_write_b128 v50, v[52:55]
    s_mov_b32 s42, 0
    ds_read_b128 v[64:67], v39 offset:0
    ds_read_b128 v[68:71], v39 offset:1024
    ds_read_b128 v[72:75], v39 offset:2048
    ds_read_b128 v[76:79], v39 offset:3072
    ds_read_b128 v[80:83], v39 offset:4112
    ds_read_b128 v[84:87], v39 offset:5136
    ds_read_b128 v[88:91], v39 offset:6160
    ds_read_b128 v[92:95], v39 offset:7184
    s_and_b32 s64, s17, 3
    s_lshl_b32 s64, s64, 2
    s_lshr_b32 s64, 0x1023, s64
    s_and_b32 s64, s64, 3
    s_andn2_b32 s65, 4, s17
    s_lshl_b32 s66, s17, 9
    s_add_u32 s66, s66, s40
    s_waitcnt lgkmcnt(0)
    s_add_u32 s43, s65, 2
    s_lshl_b32 s44, s43, 9
    s_add_u32 s44, s44, s40
    s_lshl_b32 s43, s43, 15
    s_add_u32 s43, s43, s37
    s_mov_b64 exec, 1
H_FLAG1:
    s_sub_u32 s101, s101, 1
    s_cbranch_scc1 K_END
    buffer_load_dwordx2 v[20:21], v11, s[28:31], s44 offen sc1
    s_waitcnt vmcnt(0)
    v_cmp_eq_u64 vcc, s[32:33], v[20:21]
    s_cbranch_vccz H_FLAG1
    s_mov_b64 exec, -1
    s_add_u32 m0, s36, 32896
    s_add_u32 s44, s43, 0
    buffer_load_dwordx4 v1, s[28:31], s44 offen offset:0 sc1 lds
    buffer_load_dwordx4 v1, s[28:31], s44 offen offset:1024 sc1 lds
    buffer_load_dwordx4 v1, s[28:31], s44 offen offset:2048 sc1 lds
    buffer_load_dwordx4 v1, s[28:31], s44 offen offset:3072 sc1 lds
    s_add_u32 m0, s36, 37008
    s_add_u32 s44, s43, 4096
    buffer_load_dwordx4 v1, s[28:31], s44 offen offset:0 sc1 lds
    buffer_load_dwordx4 v1, s[28:31], s44 offen offset:1024 sc1 lds
    buffer_load_dwordx4 v1, s[28:31], s44 offen offset:2048 sc1 lds
    buffer_load_dwordx4 v1, s[28:31], s44 offen offset:3072 sc1 lds
    s_waitcnt vmcnt(0)
    ds_add_u32 v44, v45
    s_bitcmp1_b32 6, s64
    s_cbranch_scc0 H_NOPUBL1
    buffer_store_dwordx4 v[64:67], v1, s[28:31], s38 offen offset:0 sc1
    buffer_store_dwordx4 v[68:71], v1, s[28:31], s38 offen offset:1024 sc1
    buffer_store_dwordx4 v[72:75], v1, s[28:31], s38 offen offset:2048 sc1
    buffer_store_dwordx4 v[76:79], v1, s[28:31], s38 offen offset:3072 sc1
    buffer_store_dwordx4 v[80:83], v1, s[28:31], s39 offen offset:0 sc1
    buffer_store_dwordx4 v[84:87], v1, s[28:31], s39 offen offset:1024 sc1
    buffer_store_dwordx4 v[88:91], v1, s[28:31], s39 offen offset:2048 sc1
    buffer_store_dwordx4 v[92:95], v1, s[28:31], s39 offen offset:3072 sc1
    s_waitcnt vmcnt(0)
    s_mov_b64 exec, 1
    buffer_store_dwordx2 v[2:3], v11, s[28:31], s66 offen sc1
    s_mov_b64 exec, -1
H_NOPUBL1:
    s_add_u32 s43, s65, 3
    s_lshl_b32 s44, s43, 9
    s_add_u32 s44, s44, s40
    s_lshl_b32 s43, s43, 15
    s_add_u32 s43, s43, s37
    s_mov_b64 exec, 1
H_FLAG2:
    s_sub_u32 s101, s101, 1
    s_cbranch_scc1 K_END
    buffer_load_dwordx2 v[20:21], v11, s[28:31], s44 offen sc1
    s_waitcnt vmcnt(0)
    v_cmp_eq_u64 vcc, s[32:33], v[20:21]
    s_cbranch_vccz H_FLAG2
    s_mov_b64 exec, -1
    s_add_u32 m0, s36, 65792
    s_add_u32 s44, s43, 0
    buffer_load_dwordx4 v1, s[28:31], s44 offen offset:0 sc1 lds
    buffer_load_dwordx4 v1, s[28:31], s44 offen offset:1024 sc1 lds
    buffer_load_dwordx4 v1, s[28:31], s44 offen offset:2048 sc1 lds
    buffer_load_dwordx4 v1, s[28:31], s44 offen offset:3072 sc1 lds
    s_add_u32 m0, s36, 69904
    s_add_u32 s44, s43, 4096
    buffer_load_dwordx4 v1, s[28:31], s44 offen offset:0 sc1 lds
    buffer_load_dwordx4 v1, s[28:31], s44 offen offset:1024 sc1 lds
    buffer_load_dwordx4 v1, s[28:31], s44 offen offset:2048 sc1 lds
    buffer_load_dwordx4 v1, s[28:31], s44 offen offset:3072 sc1 lds
    s_waitcnt vmcnt(0)
    ds_add_u32 v44, v45
    s_bitcmp1_b32 8, s64
    s_cbranch_scc0 H_NOPUBL2
    buffer_store_dwordx4 v[64:67], v1, s[28:31], s38 offen offset:0 sc1
    buffer_store_dwordx4 v[68:71], v1, s[28:31], s38 offen offset:1024 sc1
    buffer_store_dwordx4 v[72:75], v1, s[28:31], s38 offen offset:2048 sc1
    buffer_store_dwordx4 v[76:79], v1, s[28:31], s38 offen offset:3072 sc1
    buffer_store_dwordx4 v[80:83], v1, s[28:31], s39 offen offset:0 sc1
    buffer_store_dwordx4 v[84:87], v1, s[28:31], s39 offen offset:1024 sc1
    buffer_store_dwordx4 v[88:91], v1, s[28:31], s39 offen offset:2048 sc1
    buffer_store_dwordx4 v[92:95], v1, s[28:31], s39 offen offset:3072 sc1
    s_waitcnt vmcnt(0)
    s_mov_b64 exec, 1
    buffer_store_dwordx2 v[2:3], v11, s[28:31], s66 offen sc1
    s_mov_b64 exec, -1
H_NOPUBL2:
    s_add_u32 s43, s65, 1
    s_lshl_b32 s44, s43, 9
    s_add_u32 s44, s44, s40
    s_lshl_b32 s43, s43, 15
    s_add_u32 s43, s43, s37
    s_mov_b64 exec, 1
H_FLAG3:
    s_sub_u32 s101, s101, 1
    s_cbranch_scc1 K_END
    buffer_load_dwordx2 v[20:21], v11, s[28:31], s44 offen sc1
    s_waitcnt vmcnt(0)
    v_cmp_eq_u64 vcc, s[32:33], v[20:21]
    s_cbranch_vccz H_FLAG3
    s_mov_b64 exec, -1
    s_add_u32 m0, s36, 98688
    s_add_u32 s44, s43, 0
    buffer_load_dwordx4 v1, s[28:31], s44 offen offset:0 sc1 lds
    buffer_load_dwordx4 v1, s[28:31], s44 offen offset:1024 sc1 lds
    buffer_load_dwordx4 v1, s[28:31], s44 offen offset:2048 sc1 lds
    buffer_load_dwordx4 v1, s[28:31], s44 offen offset:3072 sc1 lds
    s_add_u32 m0, s36, 102800
    s_add_u32 s44, s43, 4096
    buffer_load_dwordx4 v1, s[28:31], s44 offen offset:0 sc1 lds
    buffer_load_dwordx4 v1, s[28:31], s44 offen offset:1024 sc1 lds
    buffer_load_dwordx4 v1, s[28:31], s44 offen offset:2048 sc1 lds
    buffer_load_dwordx4 v1, s[28:31], s44 offen offset:3072 sc1 lds
    s_waitcnt vmcnt(0)
    ds_add_u32 v44, v45
    s_lshl_b32 s43, s17, 3
    s_lshl_b32 s44, s16, 1
    s_add_u32 s43, s43, s44
    s_lshl_b32 s43, s43, 16
    s_lshl_b32 s44, s18, 11
    s_add_u32 s43, s43, s44
    s_add_u32 s43, s43, 0x800000
    s_add_u32 s44, s43, 0x10000
    buffer_store_dwordx4 v[40:43], v1, s[28:31], s43 offen offset:0 sc1
    buffer_store_dwordx4 v[40:43], v1, s[28:31], s43 offen offset:1024 sc1
    buffer_store_dwordx4 v[40:43], v1, s[28:31], s44 offen offset:0 sc1
    buffer_store_dwordx4 v[40:43], v1, s[28:31], s44 offen offset:1024 sc1
H_RELB4:
    s_sub_u32 s101, s101, 1
    s_cbranch_scc1 K_END
    ds_read_b32 v22, v14
    s_waitcnt lgkmcnt(0)
    v_cmp_gt_u32 vcc, 2, v22
    s_cbranch_vccz H_RELOKB4
    s_sleep 12
    s_branch H_RELB4
H_RELOKB4:
    s_add_u32 s43, s65, 0
    s_lshl_b32 s44, s43, 9
    s_add_u32 s44, s44, s40
    s_lshl_b32 s43, s43, 15
    s_add_u32 s43, s43, s37
    s_mov_b64 exec, 1
H_FLAG4:
    s_sub_u32 s101, s101, 1
    s_cbranch_scc1 K_END
    buffer_load_dwordx2 v[20:21], v11, s[28:31], s44 offen sc1
    s_waitcnt vmcnt(0)
    v_cmp_eq_u64 vcc, s[32:33], v[20:21]
    s_cbranch_vccz H_FLAG4
    s_mov_b64 exec, -1
    s_add_u32 m0, s36, 0
    s_add_u32 s44, s43, 0
    buffer_load_dwordx4 v1, s[28:31], s44 offen offset:0 sc1 lds
    buffer_load_dwordx4 v1, s[28:31], s44 offen offset:1024 sc1 lds
    buffer_load_dwordx4 v1, s[28:31], s44 offen offset:2048 sc1 lds
    buffer_load_dwordx4 v1, s[28:31], s44 offen offset:3072 sc1 lds
    s_add_u32 m0, s36, 4112
    s_add_u32 s44, s43, 4096
    buffer_load_dwordx4 v1, s[28:31], s44 offen offset:0 sc1 lds
    buffer_load_dwordx4 v1, s[28:31], s44 offen offset:1024 sc1 lds
    buffer_load_dwordx4 v1, s[28:31], s44 offen offset:2048 sc1 lds
    buffer_load_dwordx4 v1, s[28:31], s44 offen offset:3072 sc1 lds
    s_waitcnt vmcnt(0)
    ds_add_u32 v44, v45
    s_lshl_b32 s43, s17, 2
    s_add_u32 s44, s43, s16
    s_lshl_b32 s44, s44, 5
    s_add_u32 s44, s44, s18
    s_lshl_b32 s44, s44, 7
    s_add_u32 s44, s44, 0xc20000
    s_mov_b64 exec, 1
    buffer_store_dwordx2 v[2:3], v11, s[28:31], s44 offen sc1
    s_mov_b64 exec, -1
    s_add_u32 s43, s43, s19
    s_lshl_b32 s43, s43, 1
    s_add_u32 s43, s43, s34
    s_lshl_b32 s43, s43, 11
    s_add_u32 s45, s43, 0xc20000
    s_mul_i32 s46, s16, 6144
    s_add_u32 s46, s46, 131584
    s_lshl_b32 s47, s3, 7
    s_lshr_b32 s59, s19, 1
    s_lshr_b32 s58, s3, 2
    s_cmp_eq_u32 s59, s34
    s_cselect_b32 s58, s19, s19
    s_and_b32 s58, s58, 1
    s_and_b32 s60, s3, 0
    s_lshl_b32 s60, s60, 16
    s_lshl_b32 s57, s58, 18
    s_xor_b32 s56, s57, 0x40000
    s_add_u32 s56, s56, s47
    s_add_u32 s57, s57, s47
    s_add_u32 m0, s46, 0
    s_add_u32 s43, s60, 0
    s_and_b32 s43, s43, 0x3ffff
    s_add_u32 s43, s43, s56
    buffer_load_dwordx4 v46, s[20:23], s43 offen lds
    s_add_u32 m0, s46, 1024
    s_add_u32 s43, s60, 8192
    s_and_b32 s43, s43, 0x3ffff
    s_add_u32 s43, s43, s56
    buffer_load_dwordx4 v46, s[20:23], s43 offen lds
    s_add_u32 m0, s46, 2048
    s_add_u32 s43, s60, 16384
    s_and_b32 s43, s43, 0x3ffff
    s_add_u32 s43, s43, s56
    buffer_load_dwordx4 v46, s[20:23], s43 offen lds
    s_add_u32 m0, s46, 3072
    s_add_u32 s43, s60, 24576
    s_and_b32 s43, s43, 0x3ffff
    s_add_u32 s43, s43, s56
    buffer_load_dwordx4 v46, s[20:23], s43 offen lds
    s_waitcnt vmcnt(0)
    ds_read_b64_tr_b16 v[224:225], v47 offset:0
    ds_read_b64_tr_b16 v[226:227], v47 offset:512
    ds_read_b64_tr_b16 v[228:229], v48 offset:0
    ds_read_b64_tr_b16 v[230:231], v48 offset:512
    ds_read_b64_tr_b16 v[232:233], v47 offset:2048
    ds_read_b64_tr_b16 v[234:235], v47 offset:2560
    ds_read_b64_tr_b16 v[236:237], v48 offset:2048
    ds_read_b64_tr_b16 v[238:239], v48 offset:2560
    s_waitcnt lgkmcnt(0)
    s_add_u32 m0, s46, 0
    s_add_u32 s43, s60, 0
    s_and_b32 s43, s43, 0x3ffff
    s_add_u32 s43, s43, s57
    buffer_load_dwordx4 v46, s[20:23], s43 offen lds
    s_add_u32 m0, s46, 1024
    s_add_u32 s43, s60, 8192
    s_and_b32 s43, s43, 0x3ffff
    s_add_u32 s43, s43, s57
    buffer_load_dwordx4 v46, s[20:23], s43 offen lds
    s_add_u32 m0, s46, 2048
    s_add_u32 s43, s60, 16384
    s_and_b32 s43, s43, 0x3ffff
    s_add_u32 s43, s43, s57
    buffer_load_dwordx4 v46, s[20:23], s43 offen lds
    s_add_u32 m0, s46, 3072
    s_add_u32 s43, s60, 24576
    s_and_b32 s43, s43, 0x3ffff
    s_add_u32 s43, s43, s57
    buffer_load_dwordx4 v46, s[20:23], s43 offen lds
    s_waitcnt vmcnt(0)
    ds_read_b64_tr_b16 v[240:241], v47 offset:0
    ds_read_b64_tr_b16 v[242:243], v47 offset:512
    ds_read_b64_tr_b16 v[244:245], v48 offset:0
    ds_read_b64_tr_b16 v[246:247], v48 offset:512
    ds_read_b64_tr_b16 v[248:249], v47 offset:2048
    ds_read_b64_tr_b16 v[250:251], v47 offset:2560
    ds_read_b64_tr_b16 v[252:253], v48 offset:2048
    ds_read_b64_tr_b16 v[254:255], v48 offset:2560
    s_waitcnt lgkmcnt(0)
H_RELB5:
    s_sub_u32 s101, s101, 1
    s_cbranch_scc1 K_END
    ds_read_b32 v22, v14
    s_waitcnt lgkmcnt(0)
    v_cmp_gt_u32 vcc, 3, v22
    s_cbranch_vccz H_RELOKB5
    s_sleep 12
    s_branch H_RELB5
H_RELOKB5:
    s_xor_b32 s43, s17, 1
    s_lshl_b32 s44, s43, 9
    s_add_u32 s44, s44, s40
    s_lshl_b32 s43, s43, 15
    s_add_u32 s43, s43, s37
    s_mov_b64 exec, 1
H_FLAG5:
    s_sub_u32 s101, s101, 1
    s_cbranch_scc1 K_END
    buffer_load_dwordx2 v[20:21], v11, s[28:31], s44 offen sc1
    s_waitcnt vmcnt(0)
    v_cmp_eq_u64 vcc, s[32:33], v[20:21]
    s_cbranch_vccz H_FLAG5
    s_mov_b64 exec, -1
    s_add_u32 m0, s36, 32896
    s_add_u32 s44, s43, 0
    buffer_load_dwordx4 v1, s[28:31], s44 offen offset:0 sc1 lds
    buffer_load_dwordx4 v1, s[28:31], s44 offen offset:1024 sc1 lds
    buffer_load_dwordx4 v1, s[28:31], s44 offen offset:2048 sc1 lds
    buffer_load_dwordx4 v1, s[28:31], s44 offen offset:3072 sc1 lds
    s_add_u32 m0, s36, 37008
    s_add_u32 s44, s43, 4096
    buffer_load_dwordx4 v1, s[28:31], s44 offen offset:0 sc1 lds
    buffer_load_dwordx4 v1, s[28:31], s44 offen offset:1024 sc1 lds
    buffer_load_dwordx4 v1, s[28:31], s44 offen offset:2048 sc1 lds
    buffer_load_dwordx4 v1, s[28:31], s44 offen offset:3072 sc1 lds
    s_waitcnt vmcnt(0)
    ds_add_u32 v44, v45
    s_lshl_b32 s43, s35, 13
    s_add_u32 s56, s56, s43
    s_add_u32 s57, s57, s43
    s_add_u32 m0, s46, 0
    s_add_u32 s43, s60, 32768
    s_and_b32 s43, s43, 0x3ffff
    s_add_u32 s43, s43, s56
    buffer_load_dwordx4 v46, s[20:23], s43 offen lds
    s_add_u32 m0, s46, 1024
    s_add_u32 s43, s60, 49152
    s_and_b32 s43, s43, 0x3ffff
    s_add_u32 s43, s43, s56
    buffer_load_dwordx4 v46, s[20:23], s43 offen lds
    s_add_u32 m0, s46, 2048
    s_add_u32 s43, s60, 32768
    s_and_b32 s43, s43, 0x3ffff
    s_add_u32 s43, s43, s57
    buffer_load_dwordx4 v46, s[20:23], s43 offen lds
    s_add_u32 m0, s46, 3072
    s_add_u32 s43, s60, 49152
    s_and_b32 s43, s43, 0x3ffff
    s_add_u32 s43, s43, s57
    buffer_load_dwordx4 v46, s[20:23], s43 offen lds
H_RELB6:
    s_sub_u32 s101, s101, 1
    s_cbranch_scc1 K_END
    ds_read_b32 v22, v14
    s_waitcnt lgkmcnt(0)
    v_cmp_gt_u32 vcc, 4, v22
    s_cbranch_vccz H_RELOKB6
    s_sleep 12
    s_branch H_RELB6
H_RELOKB6:
    s_xor_b32 s43, s17, 2
    s_lshl_b32 s44, s43, 9
    s_add_u32 s44, s44, s40
    s_lshl_b32 s43, s43, 15
    s_add_u32 s43, s43, s37
    s_mov_b64 exec, 1
H_FLAG6:
    s_sub_u32 s101, s101, 1
    s_cbranch_scc1 K_END
    buffer_load_dwordx2 v[20:21], v11, s[28:31], s44 offen sc1
    s_waitcnt vmcnt(0)
    v_cmp_eq_u64 vcc, s[32:33], v[20:21]
    s_cbranch_vccz H_FLAG6
    s_mov_b64 exec, -1
    s_add_u32 m0, s36, 65792
    s_add_u32 s44, s43, 0
    buffer_load_dwordx4 v1, s[28:31], s44 offen offset:0 sc1 lds
    buffer_load_dwordx4 v1, s[28:31], s44 offen offset:1024 sc1 lds
    buffer_load_dwordx4 v1, s[28:31], s44 offen offset:2048 sc1 lds
    buffer_load_dwordx4 v1, s[28:31], s44 offen offset:3072 sc1 lds
    s_add_u32 m0, s36, 69904
    s_add_u32 s44, s43, 4096
    buffer_load_dwordx4 v1, s[28:31], s44 offen offset:0 sc1 lds
    buffer_load_dwordx4 v1, s[28:31], s44 offen offset:1024 sc1 lds
    buffer_load_dwordx4 v1, s[28:31], s44 offen offset:2048 sc1 lds
    buffer_load_dwordx4 v1, s[28:31], s44 offen offset:3072 sc1 lds
    s_waitcnt vmcnt(0)
    ds_add_u32 v44, v45
H_RELB7:
    s_sub_u32 s101, s101, 1
    s_cbranch_scc1 K_END
    ds_read_b32 v22, v14
    s_waitcnt lgkmcnt(0)
    v_cmp_gt_u32 vcc, 5, v22
    s_cbranch_vccz H_RELOKB7
    s_sleep 12
    s_branch H_RELB7
H_RELOKB7:
    s_xor_b32 s43, s17, 3
    s_lshl_b32 s44, s43, 9
    s_add_u32 s44, s44, s40
    s_lshl_b32 s43, s43, 15
    s_add_u32 s43, s43, s37
    s_mov_b64 exec, 1
H_FLAG7:
    s_sub_u32 s101, s101, 1
    s_cbranch_scc1 K_END
    buffer_load_dwordx2 v[20:21], v11, s[28:31], s44 offen sc1
    s_waitcnt vmcnt(0)
    v_cmp_eq_u64 vcc, s[32:33], v[20:21]
    s_cbranch_vccz H_FLAG7
    s_mov_b64 exec, -1
    s_add_u32 m0, s36, 98688
    s_add_u32 s44, s43, 0
    buffer_load_dwordx4 v1, s[28:31], s44 offen offset:0 sc1 lds
    buffer_load_dwordx4 v1, s[28:31], s44 offen offset:1024 sc1 lds
    buffer_load_dwordx4 v1, s[28:31], s44 offen offset:2048 sc1 lds
    buffer_load_dwordx4 v1, s[28:31], s44 offen offset:3072 sc1 lds
    s_add_u32 m0, s36, 102800
    s_add_u32 s44, s43, 4096
    buffer_load_dwordx4 v1, s[28:31], s44 offen offset:0 sc1 lds
    buffer_load_dwordx4 v1, s[28:31], s44 offen offset:1024 sc1 lds
    buffer_load_dwordx4 v1, s[28:31], s44 offen offset:2048 sc1 lds
    buffer_load_dwordx4 v1, s[28:31], s44 offen offset:3072 sc1 lds
    s_waitcnt vmcnt(0)
    ds_add_u32 v44, v45
    ds_read_b32 v16, v49
    ds_read_b32 v17, v49 offset:256
    ds_read_b32 v18, v49 offset:512
    ds_read_b32 v19, v49 offset:768
    s_cmp_eq_u32 s34, 0
    s_cselect_b32 s43, 1.0, -1.0
    s_cselect_b32 s44, 0, 1.0
    v_mov_b32 v20, s44
    s_waitcnt lgkmcnt(0)
    v_add_f32 v16, v16, v17
    v_add_f32 v18, v18, v19
    v_add_f32 v16, v16, v18
    v_mul_f32 v16, 0xbfb8aa3b, v16
    v_exp_f32 v16, v16
    s_nop 0
    v_add_f32 v16, 1.0, v16
    v_rcp_f32 v16, v16
    s_nop 0
    v_fma_f32 v13, v16, s43, v20
H_F2:
    s_sub_u32 s101, s101, 1
    s_cbranch_scc1 K_END
    s_mov_b64 exec, 0xffff
    buffer_load_dwordx2 v[16:17], v38, s[28:31], s45 offen sc1
    s_waitcnt vmcnt(0)
    v_cmp_eq_u64 vcc, s[32:33], v[16:17]
    s_mov_b64 exec, -1
    s_cmp_eq_u32 vcc_lo, 0xffff
    s_cbranch_scc0 H_F2
    s_lshl_b32 s46, s34, 14
    s_lshl_b32 s43, s35, 10
    s_add_u32 s46, s46, s43
H_RELW0:
    s_sub_u32 s101, s101, 1
    s_cbranch_scc1 K_END
    ds_read_b32 v22, v14
    s_waitcnt lgkmcnt(0)
    v_cmp_gt_u32 vcc, 6, v22
    s_cbranch_vccz H_RELOKW0
    s_sleep 12
    s_branch H_RELW0
H_RELOKW0:
    s_add_u32 m0, s46, 0
    s_add_u32 s43, s60, 65536
    s_and_b32 s43, s43, 0x3ffff
    s_add_u32 s43, s43, s56
    buffer_load_dwordx4 v46, s[20:23], s43 offen lds
    s_add_u32 m0, s46, 2048
    s_add_u32 s43, s60, 81920
    s_and_b32 s43, s43, 0x3ffff
    s_add_u32 s43, s43, s56
    buffer_load_dwordx4 v46, s[20:23], s43 offen lds
    s_add_u32 m0, s46, 4096
    s_add_u32 s43, s60, 98304
    s_and_b32 s43, s43, 0x3ffff
    s_add_u32 s43, s43, s56
    buffer_load_dwordx4 v46, s[20:23], s43 offen lds
    s_add_u32 m0, s46, 6144
    s_add_u32 s43, s60, 114688
    s_and_b32 s43, s43, 0x3ffff
    s_add_u32 s43, s43, s56
    buffer_load_dwordx4 v46, s[20:23], s43 offen lds
    s_add_u32 m0, s46, 8192
    s_add_u32 s43, s60, 131072
    s_and_b32 s43, s43, 0x3ffff
    s_add_u32 s43, s43, s56
    buffer_load_dwordx4 v46, s[20:23], s43 offen lds
    s_add_u32 m0, s46, 10240
    s_add_u32 s43, s60, 147456
    s_and_b32 s43, s43, 0x3ffff
    s_add_u32 s43, s43, s56
    buffer_load_dwordx4 v46, s[20:23], s43 offen lds
    s_add_u32 m0, s46, 12288
    s_add_u32 s43, s60, 163840
    s_and_b32 s43, s43, 0x3ffff
    s_add_u32 s43, s43, s56
    buffer_load_dwordx4 v46, s[20:23], s43 offen lds
    s_add_u32 m0, s46, 14336
    s_add_u32 s43, s60, 180224
    s_and_b32 s43, s43, 0x3ffff
    s_add_u32 s43, s43, s56
    buffer_load_dwordx4 v46, s[20:23], s43 offen lds
H_RELW1:
    s_sub_u32 s101, s101, 1
    s_cbranch_scc1 K_END
    ds_read_b32 v22, v14
    s_waitcnt lgkmcnt(0)
    v_cmp_gt_u32 vcc, 7, v22
    s_cbranch_vccz H_RELOKW1
    s_sleep 12
    s_branch H_RELW1
H_RELOKW1:
    s_add_u32 m0, s46, 32768
    s_add_u32 s43, s60, 196608
    s_and_b32 s43, s43, 0x3ffff
    s_add_u32 s43, s43, s56
    buffer_load_dwordx4 v46, s[20:23], s43 offen lds
    s_add_u32 m0, s46, 34816
    s_add_u32 s43, s60, 212992
    s_and_b32 s43, s43, 0x3ffff
    s_add_u32 s43, s43, s56
    buffer_load_dwordx4 v46, s[20:23], s43 offen lds
    s_add_u32 m0, s46, 36864
    s_add_u32 s43, s60, 229376
    s_and_b32 s43, s43, 0x3ffff
    s_add_u32 s43, s43, s56
    buffer_load_dwordx4 v46, s[20:23], s43 offen lds
    s_add_u32 m0, s46, 38912
    s_add_u32 s43, s60, 245760
    s_and_b32 s43, s43, 0x3ffff
    s_add_u32 s43, s43, s56
    buffer_load_dwordx4 v46, s[20:23], s43 offen lds
    s_add_u32 m0, s46, 40960
    s_add_u32 s43, s60, 65536
    s_and_b32 s43, s43, 0x3ffff
    s_add_u32 s43, s43, s57
    buffer_load_dwordx4 v46, s[20:23], s43 offen lds
    s_add_u32 m0, s46, 43008
    s_add_u32 s43, s60, 81920
    s_and_b32 s43, s43, 0x3ffff
    s_add_u32 s43, s43, s57
    buffer_load_dwordx4 v46, s[20:23], s43 offen lds
    s_add_u32 m0, s46, 45056
    s_add_u32 s43, s60, 98304
    s_and_b32 s43, s43, 0x3ffff
    s_add_u32 s43, s43, s57
    buffer_load_dwordx4 v46, s[20:23], s43 offen lds
    s_add_u32 m0, s46, 47104
    s_add_u32 s43, s60, 114688
    s_and_b32 s43, s43, 0x3ffff
    s_add_u32 s43, s43, s57
    buffer_load_dwordx4 v46, s[20:23], s43 offen lds
H_RELW2:
    s_sub_u32 s101, s101, 1
    s_cbranch_scc1 K_END
    ds_read_b32 v22, v14
    s_waitcnt lgkmcnt(0)
    v_cmp_gt_u32 vcc, 8, v22
    s_cbranch_vccz H_RELOKW2
    s_sleep 12
    s_branch H_RELW2
H_RELOKW2:
    s_add_u32 m0, s46, 65536
    s_add_u32 s43, s60, 131072
    s_and_b32 s43, s43, 0x3ffff
    s_add_u32 s43, s43, s57
    buffer_load_dwordx4 v46, s[20:23], s43 offen lds
    s_add_u32 m0, s46, 67584
    s_add_u32 s43, s60, 147456
    s_and_b32 s43, s43, 0x3ffff
    s_add_u32 s43, s43, s57
    buffer_load_dwordx4 v46, s[20:23], s43 offen lds
    s_add_u32 m0, s46, 69632
    s_add_u32 s43, s60, 163840
    s_and_b32 s43, s43, 0x3ffff
    s_add_u32 s43, s43, s57
    buffer_load_dwordx4 v46, s[20:23], s43 offen lds
    s_add_u32 m0, s46, 71680
    s_add_u32 s43, s60, 180224
    s_and_b32 s43, s43, 0x3ffff
    s_add_u32 s43, s43, s57
    buffer_load_dwordx4 v46, s[20:23], s43 offen lds
    s_add_u32 m0, s46, 73728
    s_add_u32 s43, s60, 196608
    s_and_b32 s43, s43, 0x3ffff
    s_add_u32 s43, s43, s57
    buffer_load_dwordx4 v46, s[20:23], s43 offen lds
    s_add_u32 m0, s46, 75776
    s_add_u32 s43, s60, 212992
    s_and_b32 s43, s43, 0x3ffff
    s_add_u32 s43, s43, s57
    buffer_load_dwordx4 v46, s[20:23], s43 offen lds
    s_add_u32 m0, s46, 77824
    s_add_u32 s43, s60, 229376
    s_and_b32 s43, s43, 0x3ffff
    s_add_u32 s43, s43, s57
    buffer_load_dwordx4 v46, s[20:23], s43 offen lds
    s_add_u32 m0, s46, 79872
    s_add_u32 s43, s60, 245760
    s_and_b32 s43, s43, 0x3ffff
    s_add_u32 s43, s43, s57
    buffer_load_dwordx4 v46, s[20:23], s43 offen lds
    s_lshl_b32 s43, s17, 3
    s_lshl_b32 s44, s19, 1
    s_add_u32 s43, s43, s44
    s_add_u32 s43, s43, s35
    s_lshl_b32 s44, s43, 16
    s_lshl_b32 s45, s34, 15
    s_add_u32 s44, s44, s45
    s_add_u32 s44, s44, 0x800000
    s_lshl_b32 s45, s58, 14
    s_add_u32 s44, s44, s45
    s_lshr_b32 s60, s60, 4
    s_add_u32 s45, s60, 0
    s_and_b32 s45, s45, 0x3fff
    s_add_u32 s52, s44, s45
    s_xor_b32 s48, s52, 0x4000
    s_add_u32 s45, s60, 4096
    s_and_b32 s45, s45, 0x3fff
    s_add_u32 s53, s44, s45
    s_xor_b32 s49, s53, 0x4000
    s_add_u32 s45, s60, 8192
    s_and_b32 s45, s45, 0x3fff
    s_add_u32 s54, s44, s45
    s_xor_b32 s50, s54, 0x4000
    s_add_u32 s45, s60, 12288
    s_and_b32 s45, s45, 0x3fff
    s_add_u32 s55, s44, s45
    s_xor_b32 s51, s55, 0x4000
    s_lshl_b32 s43, s43, 15
    s_lshl_b32 s44, s3, 7
    s_add_u32 s43, s43, s44
    s_lshl_b32 s44, s34, 5
    s_add_u32 s43, s43, s44
    s_waitcnt vmcnt(0)
    s_barrier
H_F0:
    buffer_load_dwordx4 v[64:67], v1, s[28:31], s48 offen offset:0 sc1
    buffer_load_dwordx4 v[68:71], v1, s[28:31], s48 offen offset:1024 sc1
    buffer_load_dwordx4 v[72:75], v1, s[28:31], s48 offen offset:2048 sc1
    buffer_load_dwordx4 v[76:79], v1, s[28:31], s48 offen offset:3072 sc1
    buffer_load_dwordx4 v[80:83], v1, s[28:31], s49 offen offset:0 sc1
    buffer_load_dwordx4 v[84:87], v1, s[28:31], s49 offen offset:1024 sc1
    buffer_load_dwordx4 v[88:91], v1, s[28:31], s49 offen offset:2048 sc1
    buffer_load_dwordx4 v[92:95], v1, s[28:31], s49 offen offset:3072 sc1
    s_waitcnt vmcnt(4)
    v_max3_u32 v11, v67, v71, v75
    v_max_u32 v11, v11, v79
    v_cmp_eq_u32 vcc, -1, v11
    s_cbranch_vccnz H_SW
H_GOF0:
    v_mfma_f32_32x32x16_bf16 v[32:47], v[224:227], v[64:67], 0
    buffer_load_dwordx4 v[96:99], v1, s[28:31], s50 offen offset:0 sc1
    buffer_load_dwordx4 v[100:103], v1, s[28:31], s50 offen offset:1024 sc1
    v_mfma_f32_32x32x16_bf16 v[48:63], v[228:231], v[64:67], 0
    v_mfma_f32_32x32x16_bf16 v[32:47], v[232:235], v[68:71], v[32:47]
    ds_read_b64_tr_b16 v[16:17], v12 offset:0
    ds_read_b64_tr_b16 v[18:19], v12 offset:512
    ds_read_b64_tr_b16 v[20:21], v15 offset:0
    ds_read_b64_tr_b16 v[22:23], v15 offset:512
    buffer_load_dwordx4 v[104:107], v1, s[28:31], s50 offen offset:2048 sc1
    buffer_load_dwordx4 v[108:111], v1, s[28:31], s50 offen offset:3072 sc1
    v_mfma_f32_32x32x16_bf16 v[48:63], v[236:239], v[68:71], v[48:63]
    s_waitcnt lgkmcnt(0)
    v_mfma_f32_32x32x16_bf16 v[32:47], v[16:19], v[72:75], v[32:47]
    ds_read_b64_tr_b16 v[24:25], v12 offset:1024
    ds_read_b64_tr_b16 v[26:27], v12 offset:1536
    ds_read_b64_tr_b16 v[28:29], v15 offset:1024
    ds_read_b64_tr_b16 v[30:31], v15 offset:1536
    v_mfma_f32_32x32x16_bf16 v[48:63], v[20:23], v[72:75], v[48:63]
    s_waitcnt lgkmcnt(0)
    v_mfma_f32_32x32x16_bf16 v[32:47], v[24:27], v[76:79], v[32:47]
    ds_read_b64_tr_b16 v[16:17], v8 offset:0
    ds_read_b64_tr_b16 v[18:19], v8 offset:512
    ds_read_b64_tr_b16 v[20:21], v9 offset:0
    ds_read_b64_tr_b16 v[22:23], v9 offset:512
    s_waitcnt vmcnt(4)
    v_max3_u32 v11, v83, v87, v91
    v_max_u32 v11, v11, v95
    v_cmp_eq_u32 vcc, -1, v11
    v_mfma_f32_32x32x16_bf16 v[48:63], v[28:31], v[76:79], v[48:63]
    s_cbranch_vccnz H_RTF1
H_GOF1:
    s_waitcnt lgkmcnt(0)
    v_mfma_f32_32x32x16_bf16 v[32:47], v[16:19], v[80:83], v[32:47]
    ds_read_b64_tr_b16 v[24:25], v8 offset:2048
    ds_read_b64_tr_b16 v[26:27], v8 offset:2560
    ds_read_b64_tr_b16 v[28:29], v9 offset:2048
    ds_read_b64_tr_b16 v[30:31], v9 offset:2560
    buffer_load_dwordx4 v[112:115], v1, s[28:31], s51 offen offset:0 sc1
    buffer_load_dwordx4 v[116:119], v1, s[28:31], s51 offen offset:1024 sc1
    v_mfma_f32_32x32x16_bf16 v[48:63], v[20:23], v[80:83], v[48:63]
    s_waitcnt lgkmcnt(0)
    v_mfma_f32_32x32x16_bf16 v[32:47], v[24:27], v[84:87], v[32:47]
    ds_read_b64_tr_b16 v[16:17], v8 offset:4096
    ds_read_b64_tr_b16 v[18:19], v8 offset:4608
    ds_read_b64_tr_b16 v[20:21], v9 offset:4096
    ds_read_b64_tr_b16 v[22:23], v9 offset:4608
    buffer_load_dwordx4 v[120:123], v1, s[28:31], s51 offen offset:2048 sc1
    buffer_load_dwordx4 v[124:127], v1, s[28:31], s51 offen offset:3072 sc1
    v_mfma_f32_32x32x16_bf16 v[48:63], v[28:31], v[84:87], v[48:63]
    s_waitcnt lgkmcnt(0)
    v_mfma_f32_32x32x16_bf16 v[32:47], v[16:19], v[88:91], v[32:47]
    ds_read_b64_tr_b16 v[24:25], v8 offset:6144
    ds_read_b64_tr_b16 v[26:27], v8 offset:6656
    ds_read_b64_tr_b16 v[28:29], v9 offset:6144
    ds_read_b64_tr_b16 v[30:31], v9 offset:6656
    v_mfma_f32_32x32x16_bf16 v[48:63], v[20:23], v[88:91], v[48:63]
    s_waitcnt lgkmcnt(0)
    v_mfma_f32_32x32x16_bf16 v[32:47], v[24:27], v[92:95], v[32:47]
    ds_read_b64_tr_b16 v[16:17], v8 offset:8192
    ds_read_b64_tr_b16 v[18:19], v8 offset:8704
    ds_read_b64_tr_b16 v[20:21], v9 offset:8192
    ds_read_b64_tr_b16 v[22:23], v9 offset:8704
    s_waitcnt vmcnt(4)
    v_max3_u32 v11, v99, v103, v107
    v_max_u32 v11, v11, v111
    v_cmp_eq_u32 vcc, -1, v11
    v_mfma_f32_32x32x16_bf16 v[48:63], v[28:31], v[92:95], v[48:63]
    s_cbranch_vccnz H_RTF2
H_GOF2:
    s_waitcnt lgkmcnt(0)
    v_mfma_f32_32x32x16_bf16 v[32:47], v[16:19], v[96:99], v[32:47]
    ds_read_b64_tr_b16 v[24:25], v8 offset:10240
    ds_read_b64_tr_b16 v[26:27], v8 offset:10752
    ds_read_b64_tr_b16 v[28:29], v9 offset:10240
    ds_read_b64_tr_b16 v[30:31], v9 offset:10752
    buffer_load_dwordx4 v[128:131], v1, s[28:31], s52 offen offset:0 sc1
    buffer_load_dwordx4 v[132:135], v1, s[28:31], s52 offen offset:1024 sc1
    v_mfma_f32_32x32x16_bf16 v[48:63], v[20:23], v[96:99], v[48:63]
    s_waitcnt lgkmcnt(0)
    v_mfma_f32_32x32x16_bf16 v[32:47], v[24:27], v[100:103], v[32:47]
    ds_read_b64_tr_b16 v[16:17], v8 offset:12288
    ds_read_b64_tr_b16 v[18:19], v8 offset:12800
    ds_read_b64_tr_b16 v[20:21], v9 offset:12288
    ds_read_b64_tr_b16 v[22:23], v9 offset:12800
    buffer_load_dwordx4 v[136:139], v1, s[28:31], s52 offen offset:2048 sc1
    buffer_load_dwordx4 v[140:143], v1, s[28:31], s52 offen offset:3072 sc1
    v_mfma_f32_32x32x16_bf16 v[48:63], v[28:31], v[100:103], v[48:63]
    s_waitcnt lgkmcnt(0)
    v_mfma_f32_32x32x16_bf16 v[32:47], v[16:19], v[104:107], v[32:47]
    ds_read_b64_tr_b16 v[24:25], v8 offset:14336
    ds_read_b64_tr_b16 v[26:27], v8 offset:14848
    ds_read_b64_tr_b16 v[28:29], v9 offset:14336
    ds_read_b64_tr_b16 v[30:31], v9 offset:14848
    v_mfma_f32_32x32x16_bf16 v[48:63], v[20:23], v[104:107], v[48:63]
    s_waitcnt lgkmcnt(0)
    v_mfma_f32_32x32x16_bf16 v[32:47], v[24:27], v[108:111], v[32:47]
    ds_read_b64_tr_b16 v[16:17], v8 offset:32768
    ds_read_b64_tr_b16 v[18:19], v8 offset:33280
    ds_read_b64_tr_b16 v[20:21], v9 offset:32768
    ds_read_b64_tr_b16 v[22:23], v9 offset:33280
    s_waitcnt vmcnt(4)
    v_max3_u32 v11, v115, v119, v123
    v_max_u32 v11, v11, v127
    v_cmp_eq_u32 vcc, -1, v11
    v_mfma_f32_32x32x16_bf16 v[48:63], v[28:31], v[108:111], v[48:63]
    s_cbranch_vccnz H_RTF3
H_GOF3:
    s_waitcnt lgkmcnt(0)
    v_mfma_f32_32x32x16_bf16 v[32:47], v[16:19], v[112:115], v[32:47]
    ds_read_b64_tr_b16 v[24:25], v8 offset:34816
    ds_read_b64_tr_b16 v[26:27], v8 offset:35328
    ds_read_b64_tr_b16 v[28:29], v9 offset:34816
    ds_read_b64_tr_b16 v[30:31], v9 offset:35328
    buffer_load_dwordx4 v[144:147], v1, s[28:31], s53 offen offset:0 sc1
    buffer_load_dwordx4 v[148:151], v1, s[28:31], s53 offen offset:1024 sc1
    v_mfma_f32_32x32x16_bf16 v[48:63], v[20:23], v[112:115], v[48:63]
    s_waitcnt lgkmcnt(0)
    v_mfma_f32_32x32x16_bf16 v[32:47], v[24:27], v[116:119], v[32:47]
    ds_read_b64_tr_b16 v[16:17], v8 offset:36864
    ds_read_b64_tr_b16 v[18:19], v8 offset:37376
    ds_read_b64_tr_b16 v[20:21], v9 offset:36864
    ds_read_b64_tr_b16 v[22:23], v9 offset:37376
    buffer_load_dwordx4 v[152:155], v1, s[28:31], s53 offen offset:2048 sc1
    buffer_load_dwordx4 v[156:159], v1, s[28:31], s53 offen offset:3072 sc1
    v_mfma_f32_32x32x16_bf16 v[48:63], v[28:31], v[116:119], v[48:63]
    s_waitcnt lgkmcnt(0)
    v_mfma_f32_32x32x16_bf16 v[32:47], v[16:19], v[120:123], v[32:47]
    ds_read_b64_tr_b16 v[24:25], v8 offset:38912
    ds_read_b64_tr_b16 v[26:27], v8 offset:39424
    ds_read_b64_tr_b16 v[28:29], v9 offset:38912
    ds_read_b64_tr_b16 v[30:31], v9 offset:39424
    v_mfma_f32_32x32x16_bf16 v[48:63], v[20:23], v[120:123], v[48:63]
    s_waitcnt lgkmcnt(0)
    v_mfma_f32_32x32x16_bf16 v[32:47], v[24:27], v[124:127], v[32:47]
    s_waitcnt vmcnt(4)
    v_max3_u32 v11, v131, v135, v139
    v_max_u32 v11, v11, v143
    v_cmp_eq_u32 vcc, -1, v11
    v_mfma_f32_32x32x16_bf16 v[48:63], v[28:31], v[124:127], v[48:63]
    s_cbranch_vccnz H_RTF4
H_GOF4:
    v_mfma_f32_32x32x16_bf16 v[192:207], v[240:243], v[128:131], 0
    buffer_load_dwordx4 v[160:163], v1, s[28:31], s54 offen offset:0 sc1
    buffer_load_dwordx4 v[164:167], v1, s[28:31], s54 offen offset:1024 sc1
    v_mfma_f32_32x32x16_bf16 v[208:223], v[244:247], v[128:131], 0
    v_mfma_f32_32x32x16_bf16 v[192:207], v[248:251], v[132:135], v[192:207]
    ds_read_b64_tr_b16 v[16:17], v12 offset:2048
    ds_read_b64_tr_b16 v[18:19], v12 offset:2560
    ds_read_b64_tr_b16 v[20:21], v15 offset:2048
    ds_read_b64_tr_b16 v[22:23], v15 offset:2560
    buffer_load_dwordx4 v[168:171], v1, s[28:31], s54 offen offset:2048 sc1
    buffer_load_dwordx4 v[172:175], v1, s[28:31], s54 offen offset:3072 sc1
    v_mfma_f32_32x32x16_bf16 v[208:223], v[252:255], v[132:135], v[208:223]
    s_waitcnt lgkmcnt(0)
    v_mfma_f32_32x32x16_bf16 v[192:207], v[16:19], v[136:139], v[192:207]
    ds_read_b64_tr_b16 v[24:25], v12 offset:3072
    ds_read_b64_tr_b16 v[26:27], v12 offset:3584
    ds_read_b64_tr_b16 v[28:29], v15 offset:3072
    ds_read_b64_tr_b16 v[30:31], v15 offset:3584
    v_mfma_f32_32x32x16_bf16 v[208:223], v[20:23], v[136:139], v[208:223]
    v_mul_f32 v32, v32, v13
    v_mul_f32 v33, v33, v13
    v_mul_f32 v34, v34, v13
    v_mul_f32 v35, v35, v13
    v_mul_f32 v36, v36, v13
    s_waitcnt lgkmcnt(0)
    v_mfma_f32_32x32x16_bf16 v[192:207], v[24:27], v[140:143], v[192:207]
    ds_read_b64_tr_b16 v[16:17], v8 offset:40960
    ds_read_b64_tr_b16 v[18:19], v8 offset:41472
    ds_read_b64_tr_b16 v[20:21], v9 offset:40960
    ds_read_b64_tr_b16 v[22:23], v9 offset:41472
    s_waitcnt vmcnt(4)
    v_max3_u32 v11, v147, v151, v155
    v_max_u32 v11, v11, v159
    v_cmp_eq_u32 vcc, -1, v11
    v_mfma_f32_32x32x16_bf16 v[208:223], v[28:31], v[140:143], v[208:223]
    s_cbranch_vccnz H_RTF5
H_GOF5:
    s_waitcnt lgkmcnt(0)
    v_mfma_f32_32x32x16_bf16 v[192:207], v[16:19], v[144:147], v[192:207]
    ds_read_b64_tr_b16 v[24:25], v8 offset:43008
    ds_read_b64_tr_b16 v[26:27], v8 offset:43520
    ds_read_b64_tr_b16 v[28:29], v9 offset:43008
    ds_read_b64_tr_b16 v[30:31], v9 offset:43520
    buffer_load_dwordx4 v[176:179], v1, s[28:31], s55 offen offset:0 sc1
    buffer_load_dwordx4 v[180:183], v1, s[28:31], s55 offen offset:1024 sc1
    v_mfma_f32_32x32x16_bf16 v[208:223], v[20:23], v[144:147], v[208:223]
    v_mul_f32 v37, v37, v13
    v_mul_f32 v38, v38, v13
    v_mul_f32 v39, v39, v13
    v_mul_f32 v40, v40, v13
    v_mul_f32 v41, v41, v13
    s_waitcnt lgkmcnt(0)
    v_mfma_f32_32x32x16_bf16 v[192:207], v[24:27], v[148:151], v[192:207]
    ds_read_b64_tr_b16 v[16:17], v8 offset:45056
    ds_read_b64_tr_b16 v[18:19], v8 offset:45568
    ds_read_b64_tr_b16 v[20:21], v9 offset:45056
    ds_read_b64_tr_b16 v[22:23], v9 offset:45568
    buffer_load_dwordx4 v[184:187], v1, s[28:31], s55 offen offset:2048 sc1
    buffer_load_dwordx4 v[188:191], v1, s[28:31], s55 offen offset:3072 sc1
    v_mfma_f32_32x32x16_bf16 v[208:223], v[28:31], v[148:151], v[208:223]
    v_mul_f32 v42, v42, v13
    v_mul_f32 v43, v43, v13
    v_mul_f32 v44, v44, v13
    v_mul_f32 v45, v45, v13
    v_mul_f32 v46, v46, v13
    s_waitcnt lgkmcnt(0)
    v_mfma_f32_32x32x16_bf16 v[192:207], v[16:19], v[152:155], v[192:207]
    ds_read_b64_tr_b16 v[24:25], v8 offset:47104
    ds_read_b64_tr_b16 v[26:27], v8 offset:47616
    ds_read_b64_tr_b16 v[28:29], v9 offset:47104
    ds_read_b64_tr_b16 v[30:31], v9 offset:47616
    v_mfma_f32_32x32x16_bf16 v[208:223], v[20:23], v[152:155], v[208:223]
    v_mul_f32 v47, v47, v13
    v_mul_f32 v48, v48, v13
    v_mul_f32 v49, v49, v13
    v_mul_f32 v50, v50, v13
    v_mul_f32 v51, v51, v13
    s_waitcnt lgkmcnt(0)
    v_mfma_f32_32x32x16_bf16 v[192:207], v[24:27], v[156:159], v[192:207]
    ds_read_b64_tr_b16 v[16:17], v6 offset:0
    ds_read_b64_tr_b16 v[18:19], v6 offset:512
    ds_read_b64_tr_b16 v[20:21], v7 offset:0
    ds_read_b64_tr_b16 v[22:23], v7 offset:512
    s_waitcnt vmcnt(4)
    v_max3_u32 v11, v163, v167, v171
    v_max_u32 v11, v11, v175
    v_cmp_eq_u32 vcc, -1, v11
    v_mfma_f32_32x32x16_bf16 v[208:223], v[28:31], v[156:159], v[208:223]
    s_cbranch_vccnz H_RTF6
H_GOF6:
    s_waitcnt lgkmcnt(0)
    v_mfma_f32_32x32x16_bf16 v[192:207], v[16:19], v[160:163], v[192:207]
    ds_read_b64_tr_b16 v[24:25], v6 offset:2048
    ds_read_b64_tr_b16 v[26:27], v6 offset:2560
    ds_read_b64_tr_b16 v[28:29], v7 offset:2048
    ds_read_b64_tr_b16 v[30:31], v7 offset:2560
    ds_read_b64_tr_b16 v[64:65], v6 offset:10240
    ds_read_b64_tr_b16 v[66:67], v6 offset:10752
    ds_read_b64_tr_b16 v[72:73], v6 offset:12288
    v_mfma_f32_32x32x16_bf16 v[208:223], v[20:23], v[160:163], v[208:223]
    v_mul_f32 v52, v52, v13
    v_mul_f32 v53, v53, v13
    v_mul_f32 v54, v54, v13
    v_mul_f32 v55, v55, v13
    v_mul_f32 v56, v56, v13
    s_waitcnt lgkmcnt(3)
    v_mfma_f32_32x32x16_bf16 v[192:207], v[24:27], v[164:167], v[192:207]
    ds_read_b64_tr_b16 v[16:17], v6 offset:4096
    ds_read_b64_tr_b16 v[18:19], v6 offset:4608
    ds_read_b64_tr_b16 v[20:21], v7 offset:4096
    ds_read_b64_tr_b16 v[22:23], v7 offset:4608
    ds_read_b64_tr_b16 v[74:75], v6 offset:12800
    ds_read_b64_tr_b16 v[80:81], v6 offset:14336
    ds_read_b64_tr_b16 v[82:83], v6 offset:14848
    v_mfma_f32_32x32x16_bf16 v[208:223], v[28:31], v[164:167], v[208:223]
    v_mul_f32 v57, v57, v13
    v_mul_f32 v58, v58, v13
    v_mul_f32 v59, v59, v13
    v_mul_f32 v60, v60, v13
    v_mul_f32 v61, v61, v13
    s_waitcnt lgkmcnt(3)
    v_mfma_f32_32x32x16_bf16 v[192:207], v[16:19], v[168:171], v[192:207]
    ds_read_b64_tr_b16 v[24:25], v6 offset:6144
    ds_read_b64_tr_b16 v[26:27], v6 offset:6656
    ds_read_b64_tr_b16 v[28:29], v7 offset:6144
    ds_read_b64_tr_b16 v[30:31], v7 offset:6656
    ds_read_b64_tr_b16 v[68:69], v7 offset:10240
    ds_read_b64_tr_b16 v[70:71], v7 offset:10752
    ds_read_b64_tr_b16 v[76:77], v7 offset:12288
    v_mfma_f32_32x32x16_bf16 v[208:223], v[20:23], v[168:171], v[208:223]
    v_mul_f32 v62, v62, v13
    v_mul_f32 v63, v63, v13
    s_waitcnt lgkmcnt(3)
    v_mfma_f32_32x32x16_bf16 v[192:207], v[24:27], v[172:175], v[192:207]
    ds_read_b64_tr_b16 v[16:17], v6 offset:8192
    ds_read_b64_tr_b16 v[18:19], v6 offset:8704
    ds_read_b64_tr_b16 v[20:21], v7 offset:8192
    ds_read_b64_tr_b16 v[22:23], v7 offset:8704
    ds_read_b64_tr_b16 v[78:79], v7 offset:12800
    ds_read_b64_tr_b16 v[84:85], v7 offset:14336
    ds_read_b64_tr_b16 v[86:87], v7 offset:14848
    s_waitcnt vmcnt(0)
    v_max3_u32 v11, v179, v183, v187
    v_max_u32 v11, v11, v191
    v_cmp_eq_u32 vcc, -1, v11
    v_mfma_f32_32x32x16_bf16 v[208:223], v[28:31], v[172:175], v[208:223]
    s_cbranch_vccnz H_RTF7
H_GOF7:
    s_waitcnt lgkmcnt(3)
    v_mfma_f32_32x32x16_bf16 v[192:207], v[16:19], v[176:179], v[192:207]
    v_mfma_f32_32x32x16_bf16 v[192:207], v[64:67], v[180:183], v[192:207]
    v_mfma_f32_32x32x16_bf16 v[192:207], v[72:75], v[184:187], v[192:207]
    v_mfma_f32_32x32x16_bf16 v[192:207], v[80:83], v[188:191], v[192:207]
    s_waitcnt lgkmcnt(0)
    v_mfma_f32_32x32x16_bf16 v[208:223], v[20:23], v[176:179], v[208:223]
    s_nop 6
    v_mfma_f32_32x32x16_bf16 v[208:223], v[68:71], v[180:183], v[208:223]
    s_nop 2
    v_fma_f32 v32, v192, v13, v32
    v_fma_f32 v33, v193, v13, v33
    v_fma_f32 v34, v194, v13, v34
    v_fma_f32 v35, v195, v13, v35
    v_mfma_f32_32x32x16_bf16 v[208:223], v[76:79], v[184:187], v[208:223]
    ds_write_b128 v4, v[32:35] offset:0
    v_fma_f32 v36, v196, v13, v36
    v_fma_f32 v37, v197, v13, v37
    v_fma_f32 v38, v198, v13, v38
    v_fma_f32 v39, v199, v13, v39
    ds_write_b128 v4, v[36:39] offset:1024
    v_fma_f32 v40, v200, v13, v40
    v_mfma_f32_32x32x16_bf16 v[208:223], v[84:87], v[188:191], v[208:223]
    v_fma_f32 v41, v201, v13, v41
    v_fma_f32 v42, v202, v13, v42
    v_fma_f32 v43, v203, v13, v43
    ds_write_b128 v4, v[40:43] offset:2048
    v_fma_f32 v44, v204, v13, v44
    v_fma_f32 v45, v205, v13, v45
    v_fma_f32 v46, v206, v13, v46
    v_fma_f32 v47, v207, v13, v47
    ds_write_b128 v4, v[44:47] offset:3072
    s_waitcnt lgkmcnt(0)
    s_barrier
    ds_read_b128 v[96:99], v5 offset:0
    ds_read_b128 v[100:103], v5 offset:1024
    ds_read_b128 v[104:107], v5 offset:2048
    ds_read_b128 v[108:111], v5 offset:3072
    v_pk_fma_f32 v[48:49], v[208:209], v[12:13], v[48:49] op_sel:[0,1,0]
    v_pk_fma_f32 v[50:51], v[210:211], v[12:13], v[50:51] op_sel:[0,1,0]
    v_pk_fma_f32 v[52:53], v[212:213], v[12:13], v[52:53] op_sel:[0,1,0]
    v_pk_fma_f32 v[54:55], v[214:215], v[12:13], v[54:55] op_sel:[0,1,0]
    v_pk_fma_f32 v[56:57], v[216:217], v[12:13], v[56:57] op_sel:[0,1,0]
    v_pk_fma_f32 v[58:59], v[218:219], v[12:13], v[58:59] op_sel:[0,1,0]
    v_pk_fma_f32 v[60:61], v[220:221], v[12:13], v[60:61] op_sel:[0,1,0]
    v_pk_fma_f32 v[62:63], v[222:223], v[12:13], v[62:63] op_sel:[0,1,0]
H_FIN:
    s_waitcnt lgkmcnt(3)
    v_pk_add_f32 v[48:49], v[48:49], v[96:97]
    v_pk_add_f32 v[50:51], v[50:51], v[98:99]
    v_cvt_pk_bf16_f32 v16, v48, v49
    v_cvt_pk_bf16_f32 v17, v50, v51
    s_waitcnt lgkmcnt(2)
    v_pk_add_f32 v[52:53], v[52:53], v[100:101]
    v_pk_add_f32 v[54:55], v[54:55], v[102:103]
    v_cvt_pk_bf16_f32 v18, v52, v53
    v_cvt_pk_bf16_f32 v19, v54, v55
    buffer_store_dwordx4 v[16:19], v10, s[24:27], s43 offen offset:0
    s_waitcnt lgkmcnt(1)
    v_pk_add_f32 v[56:57], v[56:57], v[104:105]
    v_pk_add_f32 v[58:59], v[58:59], v[106:107]
    v_cvt_pk_bf16_f32 v20, v56, v57
    v_cvt_pk_bf16_f32 v21, v58, v59
    s_waitcnt lgkmcnt(0)
    v_pk_add_f32 v[60:61], v[60:61], v[108:109]
    v_pk_add_f32 v[62:63], v[62:63], v[110:111]
    v_cvt_pk_bf16_f32 v22, v60, v61
    v_cvt_pk_bf16_f32 v23, v62, v63
    buffer_store_dwordx4 v[20:23], v10, s[24:27], s43 offen offset:16
    s_endpgm
H_SW:
    s_sub_u32 s101, s101, 1
    s_cbranch_scc1 K_END
H_S0:
    buffer_load_dwordx4 v[128:131], v1, s[28:31], s52 offen offset:0 sc1
    buffer_load_dwordx4 v[132:135], v1, s[28:31], s52 offen offset:1024 sc1
    buffer_load_dwordx4 v[136:139], v1, s[28:31], s52 offen offset:2048 sc1
    buffer_load_dwordx4 v[140:143], v1, s[28:31], s52 offen offset:3072 sc1
    buffer_load_dwordx4 v[144:147], v1, s[28:31], s53 offen offset:0 sc1
    buffer_load_dwordx4 v[148:151], v1, s[28:31], s53 offen offset:1024 sc1
    buffer_load_dwordx4 v[152:155], v1, s[28:31], s53 offen offset:2048 sc1
    buffer_load_dwordx4 v[156:159], v1, s[28:31], s53 offen offset:3072 sc1
    s_waitcnt vmcnt(4)
    v_max3_u32 v11, v131, v135, v139
    v_max_u32 v11, v11, v143
    v_cmp_eq_u32 vcc, -1, v11
    s_cbranch_vccnz H_F0
H_GOS0:
    v_mfma_f32_32x32x16_bf16 v[192:207], v[240:243], v[128:131], 0
    buffer_load_dwordx4 v[160:163], v1, s[28:31], s54 offen offset:0 sc1
    buffer_load_dwordx4 v[164:167], v1, s[28:31], s54 offen offset:1024 sc1
    v_mfma_f32_32x32x16_bf16 v[208:223], v[244:247], v[128:131], 0
    v_mfma_f32_32x32x16_bf16 v[192:207], v[248:251], v[132:135], v[192:207]
    ds_read_b64_tr_b16 v[16:17], v12 offset:2048
    ds_read_b64_tr_b16 v[18:19], v12 offset:2560
    ds_read_b64_tr_b16 v[20:21], v15 offset:2048
    ds_read_b64_tr_b16 v[22:23], v15 offset:2560
    buffer_load_dwordx4 v[168:171], v1, s[28:31], s54 offen offset:2048 sc1
    buffer_load_dwordx4 v[172:175], v1, s[28:31], s54 offen offset:3072 sc1
    v_mfma_f32_32x32x16_bf16 v[208:223], v[252:255], v[132:135], v[208:223]
    s_waitcnt lgkmcnt(0)
    v_mfma_f32_32x32x16_bf16 v[192:207], v[16:19], v[136:139], v[192:207]
    ds_read_b64_tr_b16 v[24:25], v12 offset:3072
    ds_read_b64_tr_b16 v[26:27], v12 offset:3584
    ds_read_b64_tr_b16 v[28:29], v15 offset:3072
    ds_read_b64_tr_b16 v[30:31], v15 offset:3584
    v_mfma_f32_32x32x16_bf16 v[208:223], v[20:23], v[136:139], v[208:223]
    s_waitcnt lgkmcnt(0)
    v_mfma_f32_32x32x16_bf16 v[192:207], v[24:27], v[140:143], v[192:207]
    ds_read_b64_tr_b16 v[16:17], v8 offset:40960
    ds_read_b64_tr_b16 v[18:19], v8 offset:41472
    ds_read_b64_tr_b16 v[20:21], v9 offset:40960
    ds_read_b64_tr_b16 v[22:23], v9 offset:41472
    s_waitcnt vmcnt(4)
    v_max3_u32 v11, v147, v151, v155
    v_max_u32 v11, v11, v159
    v_cmp_eq_u32 vcc, -1, v11
    v_mfma_f32_32x32x16_bf16 v[208:223], v[28:31], v[140:143], v[208:223]
    s_cbranch_vccnz H_RTS1
H_GOS1:
    s_waitcnt lgkmcnt(0)
    v_mfma_f32_32x32x16_bf16 v[192:207], v[16:19], v[144:147], v[192:207]
    ds_read_b64_tr_b16 v[24:25], v8 offset:43008
    ds_read_b64_tr_b16 v[26:27], v8 offset:43520
    ds_read_b64_tr_b16 v[28:29], v9 offset:43008
    ds_read_b64_tr_b16 v[30:31], v9 offset:43520
    buffer_load_dwordx4 v[176:179], v1, s[28:31], s55 offen offset:0 sc1
    buffer_load_dwordx4 v[180:183], v1, s[28:31], s55 offen offset:1024 sc1
    v_mfma_f32_32x32x16_bf16 v[208:223], v[20:23], v[144:147], v[208:223]
    s_waitcnt lgkmcnt(0)
    v_mfma_f32_32x32x16_bf16 v[192:207], v[24:27], v[148:151], v[192:207]
    ds_read_b64_tr_b16 v[16:17], v8 offset:45056
    ds_read_b64_tr_b16 v[18:19], v8 offset:45568
    ds_read_b64_tr_b16 v[20:21], v9 offset:45056
    ds_read_b64_tr_b16 v[22:23], v9 offset:45568
    buffer_load_dwordx4 v[184:187], v1, s[28:31], s55 offen offset:2048 sc1
    buffer_load_dwordx4 v[188:191], v1, s[28:31], s55 offen offset:3072 sc1
    v_mfma_f32_32x32x16_bf16 v[208:223], v[28:31], v[148:151], v[208:223]
    s_waitcnt lgkmcnt(0)
    v_mfma_f32_32x32x16_bf16 v[192:207], v[16:19], v[152:155], v[192:207]
    ds_read_b64_tr_b16 v[24:25], v8 offset:47104
    ds_read_b64_tr_b16 v[26:27], v8 offset:47616
    ds_read_b64_tr_b16 v[28:29], v9 offset:47104
    ds_read_b64_tr_b16 v[30:31], v9 offset:47616
    v_mfma_f32_32x32x16_bf16 v[208:223], v[20:23], v[152:155], v[208:223]
    s_waitcnt lgkmcnt(0)
    v_mfma_f32_32x32x16_bf16 v[192:207], v[24:27], v[156:159], v[192:207]
    ds_read_b64_tr_b16 v[16:17], v6 offset:0
    ds_read_b64_tr_b16 v[18:19], v6 offset:512
    ds_read_b64_tr_b16 v[20:21], v7 offset:0
    ds_read_b64_tr_b16 v[22:23], v7 offset:512
    s_waitcnt vmcnt(4)
    v_max3_u32 v11, v163, v167, v171
    v_max_u32 v11, v11, v175
    v_cmp_eq_u32 vcc, -1, v11
    v_mfma_f32_32x32x16_bf16 v[208:223], v[28:31], v[156:159], v[208:223]
    s_cbranch_vccnz H_RTS2
H_GOS2:
    s_waitcnt lgkmcnt(0)
    v_mfma_f32_32x32x16_bf16 v[192:207], v[16:19], v[160:163], v[192:207]
    ds_read_b64_tr_b16 v[24:25], v6 offset:2048
    ds_read_b64_tr_b16 v[26:27], v6 offset:2560
    ds_read_b64_tr_b16 v[28:29], v7 offset:2048
    ds_read_b64_tr_b16 v[30:31], v7 offset:2560
    buffer_load_dwordx4 v[64:67], v1, s[28:31], s48 offen offset:0 sc1
    buffer_load_dwordx4 v[68:71], v1, s[28:31], s48 offen offset:1024 sc1
    v_mfma_f32_32x32x16_bf16 v[208:223], v[20:23], v[160:163], v[208:223]
    s_waitcnt lgkmcnt(0)
    v_mfma_f32_32x32x16_bf16 v[192:207], v[24:27], v[164:167], v[192:207]
    ds_read_b64_tr_b16 v[16:17], v6 offset:4096
    ds_read_b64_tr_b16 v[18:19], v6 offset:4608
    ds_read_b64_tr_b16 v[20:21], v7 offset:4096
    ds_read_b64_tr_b16 v[22:23], v7 offset:4608
    buffer_load_dwordx4 v[72:75], v1, s[28:31], s48 offen offset:2048 sc1
    buffer_load_dwordx4 v[76:79], v1, s[28:31], s48 offen offset:3072 sc1
    v_mfma_f32_32x32x16_bf16 v[208:223], v[28:31], v[164:167], v[208:223]
    s_waitcnt lgkmcnt(0)
    v_mfma_f32_32x32x16_bf16 v[192:207], v[16:19], v[168:171], v[192:207]
    ds_read_b64_tr_b16 v[24:25], v6 offset:6144
    ds_read_b64_tr_b16 v[26:27], v6 offset:6656
    ds_read_b64_tr_b16 v[28:29], v7 offset:6144
    ds_read_b64_tr_b16 v[30:31], v7 offset:6656
    v_mfma_f32_32x32x16_bf16 v[208:223], v[20:23], v[168:171], v[208:223]
    s_waitcnt lgkmcnt(0)
    v_mfma_f32_32x32x16_bf16 v[192:207], v[24:27], v[172:175], v[192:207]
    ds_read_b64_tr_b16 v[16:17], v6 offset:8192
    ds_read_b64_tr_b16 v[18:19], v6 offset:8704
    ds_read_b64_tr_b16 v[20:21], v7 offset:8192
    ds_read_b64_tr_b16 v[22:23], v7 offset:8704
    s_waitcnt vmcnt(4)
    v_max3_u32 v11, v179, v183, v187
    v_max_u32 v11, v11, v191
    v_cmp_eq_u32 vcc, -1, v11
    v_mfma_f32_32x32x16_bf16 v[208:223], v[28:31], v[172:175], v[208:223]
    s_cbranch_vccnz H_RTS3
H_GOS3:
    s_waitcnt lgkmcnt(0)
    v_mfma_f32_32x32x16_bf16 v[192:207], v[16:19], v[176:179], v[192:207]
    ds_read_b64_tr_b16 v[24:25], v6 offset:10240
    ds_read_b64_tr_b16 v[26:27], v6 offset:10752
    ds_read_b64_tr_b16 v[28:29], v7 offset:10240
    ds_read_b64_tr_b16 v[30:31], v7 offset:10752
    buffer_load_dwordx4 v[80:83], v1, s[28:31], s49 offen offset:0 sc1
    buffer_load_dwordx4 v[84:87], v1, s[28:31], s49 offen offset:1024 sc1
    v_mfma_f32_32x32x16_bf16 v[208:223], v[20:23], v[176:179], v[208:223]
    s_waitcnt lgkmcnt(0)
    v_mfma_f32_32x32x16_bf16 v[192:207], v[24:27], v[180:183], v[192:207]
    ds_read_b64_tr_b16 v[16:17], v6 offset:12288
    ds_read_b64_tr_b16 v[18:19], v6 offset:12800
    ds_read_b64_tr_b16 v[20:21], v7 offset:12288
    ds_read_b64_tr_b16 v[22:23], v7 offset:12800
    buffer_load_dwordx4 v[88:91], v1, s[28:31], s49 offen offset:2048 sc1
    buffer_load_dwordx4 v[92:95], v1, s[28:31], s49 offen offset:3072 sc1
    v_mfma_f32_32x32x16_bf16 v[208:223], v[28:31], v[180:183], v[208:223]
    s_waitcnt lgkmcnt(0)
    v_mfma_f32_32x32x16_bf16 v[192:207], v[16:19], v[184:187], v[192:207]
    ds_read_b64_tr_b16 v[24:25], v6 offset:14336
    ds_read_b64_tr_b16 v[26:27], v6 offset:14848
    ds_read_b64_tr_b16 v[28:29], v7 offset:14336
    ds_read_b64_tr_b16 v[30:31], v7 offset:14848
    v_mfma_f32_32x32x16_bf16 v[208:223], v[20:23], v[184:187], v[208:223]
    s_waitcnt lgkmcnt(0)
    v_mfma_f32_32x32x16_bf16 v[192:207], v[24:27], v[188:191], v[192:207]
    s_waitcnt vmcnt(4)
    v_max3_u32 v11, v67, v71, v75
    v_max_u32 v11, v11, v79
    v_cmp_eq_u32 vcc, -1, v11
    v_mfma_f32_32x32x16_bf16 v[208:223], v[28:31], v[188:191], v[208:223]
    s_cbranch_vccnz H_RTS4
H_GOS4:
    v_mfma_f32_32x32x16_bf16 v[32:47], v[224:227], v[64:67], 0
    buffer_load_dwordx4 v[96:99], v1, s[28:31], s50 offen offset:0 sc1
    buffer_load_dwordx4 v[100:103], v1, s[28:31], s50 offen offset:1024 sc1
    v_mfma_f32_32x32x16_bf16 v[48:63], v[228:231], v[64:67], 0
    v_mfma_f32_32x32x16_bf16 v[32:47], v[232:235], v[68:71], v[32:47]
    ds_read_b64_tr_b16 v[16:17], v12 offset:0
    ds_read_b64_tr_b16 v[18:19], v12 offset:512
    ds_read_b64_tr_b16 v[20:21], v15 offset:0
    ds_read_b64_tr_b16 v[22:23], v15 offset:512
    buffer_load_dwordx4 v[104:107], v1, s[28:31], s50 offen offset:2048 sc1
    buffer_load_dwordx4 v[108:111], v1, s[28:31], s50 offen offset:3072 sc1
    v_mfma_f32_32x32x16_bf16 v[48:63], v[236:239], v[68:71], v[48:63]
    s_waitcnt lgkmcnt(0)
    v_mfma_f32_32x32x16_bf16 v[32:47], v[16:19], v[72:75], v[32:47]
    ds_read_b64_tr_b16 v[24:25], v12 offset:1024
    ds_read_b64_tr_b16 v[26:27], v12 offset:1536
    ds_read_b64_tr_b16 v[28:29], v15 offset:1024
    ds_read_b64_tr_b16 v[30:31], v15 offset:1536
    v_mfma_f32_32x32x16_bf16 v[48:63], v[20:23], v[72:75], v[48:63]
    s_waitcnt lgkmcnt(0)
    v_mfma_f32_32x32x16_bf16 v[32:47], v[24:27], v[76:79], v[32:47]
    ds_read_b64_tr_b16 v[16:17], v8 offset:0
    ds_read_b64_tr_b16 v[18:19], v8 offset:512
    ds_read_b64_tr_b16 v[20:21], v9 offset:0
    ds_read_b64_tr_b16 v[22:23], v9 offset:512
    s_waitcnt vmcnt(4)
    v_max3_u32 v11, v83, v87, v91
    v_max_u32 v11, v11, v95
    v_cmp_eq_u32 vcc, -1, v11
    v_mfma_f32_32x32x16_bf16 v[48:63], v[28:31], v[76:79], v[48:63]
    s_cbranch_vccnz H_RTS5
H_GOS5:
    s_waitcnt lgkmcnt(0)
    v_mfma_f32_32x32x16_bf16 v[32:47], v[16:19], v[80:83], v[32:47]
    ds_read_b64_tr_b16 v[24:25], v8 offset:2048
    ds_read_b64_tr_b16 v[26:27], v8 offset:2560
    ds_read_b64_tr_b16 v[28:29], v9 offset:2048
    ds_read_b64_tr_b16 v[30:31], v9 offset:2560
    buffer_load_dwordx4 v[112:115], v1, s[28:31], s51 offen offset:0 sc1
    buffer_load_dwordx4 v[116:119], v1, s[28:31], s51 offen offset:1024 sc1
    v_mfma_f32_32x32x16_bf16 v[48:63], v[20:23], v[80:83], v[48:63]
    s_waitcnt lgkmcnt(0)
    v_mfma_f32_32x32x16_bf16 v[32:47], v[24:27], v[84:87], v[32:47]
    ds_read_b64_tr_b16 v[16:17], v8 offset:4096
    ds_read_b64_tr_b16 v[18:19], v8 offset:4608
    ds_read_b64_tr_b16 v[20:21], v9 offset:4096
    ds_read_b64_tr_b16 v[22:23], v9 offset:4608
    buffer_load_dwordx4 v[120:123], v1, s[28:31], s51 offen offset:2048 sc1
    buffer_load_dwordx4 v[124:127], v1, s[28:31], s51 offen offset:3072 sc1
    v_mfma_f32_32x32x16_bf16 v[48:63], v[28:31], v[84:87], v[48:63]
    s_waitcnt lgkmcnt(0)
    v_mfma_f32_32x32x16_bf16 v[32:47], v[16:19], v[88:91], v[32:47]
    ds_read_b64_tr_b16 v[24:25], v8 offset:6144
    ds_read_b64_tr_b16 v[26:27], v8 offset:6656
    ds_read_b64_tr_b16 v[28:29], v9 offset:6144
    ds_read_b64_tr_b16 v[30:31], v9 offset:6656
    v_mfma_f32_32x32x16_bf16 v[48:63], v[20:23], v[88:91], v[48:63]
    s_waitcnt lgkmcnt(0)
    v_mfma_f32_32x32x16_bf16 v[32:47], v[24:27], v[92:95], v[32:47]
    ds_read_b64_tr_b16 v[16:17], v8 offset:8192
    ds_read_b64_tr_b16 v[18:19], v8 offset:8704
    ds_read_b64_tr_b16 v[20:21], v9 offset:8192
    ds_read_b64_tr_b16 v[22:23], v9 offset:8704
    s_waitcnt vmcnt(4)
    v_max3_u32 v11, v99, v103, v107
    v_max_u32 v11, v11, v111
    v_cmp_eq_u32 vcc, -1, v11
    v_mfma_f32_32x32x16_bf16 v[48:63], v[28:31], v[92:95], v[48:63]
    s_cbranch_vccnz H_RTS6
H_GOS6:
    s_waitcnt lgkmcnt(0)
    v_mfma_f32_32x32x16_bf16 v[32:47], v[16:19], v[96:99], v[32:47]
    ds_read_b64_tr_b16 v[24:25], v8 offset:10240
    ds_read_b64_tr_b16 v[26:27], v8 offset:10752
    ds_read_b64_tr_b16 v[28:29], v9 offset:10240
    ds_read_b64_tr_b16 v[30:31], v9 offset:10752
    ds_read_b64_tr_b16 v[128:129], v8 offset:34816
    ds_read_b64_tr_b16 v[130:131], v8 offset:35328
    ds_read_b64_tr_b16 v[136:137], v8 offset:36864
    v_mfma_f32_32x32x16_bf16 v[48:63], v[20:23], v[96:99], v[48:63]
    s_waitcnt lgkmcnt(3)
    v_mfma_f32_32x32x16_bf16 v[32:47], v[24:27], v[100:103], v[32:47]
    ds_read_b64_tr_b16 v[16:17], v8 offset:12288
    ds_read_b64_tr_b16 v[18:19], v8 offset:12800
    ds_read_b64_tr_b16 v[20:21], v9 offset:12288
    ds_read_b64_tr_b16 v[22:23], v9 offset:12800
    ds_read_b64_tr_b16 v[138:139], v8 offset:37376
    ds_read_b64_tr_b16 v[144:145], v8 offset:38912
    ds_read_b64_tr_b16 v[146:147], v8 offset:39424
    v_mfma_f32_32x32x16_bf16 v[48:63], v[28:31], v[100:103], v[48:63]
    s_waitcnt lgkmcnt(3)
    v_mfma_f32_32x32x16_bf16 v[32:47], v[16:19], v[104:107], v[32:47]
    ds_read_b64_tr_b16 v[24:25], v8 offset:14336
    ds_read_b64_tr_b16 v[26:27], v8 offset:14848
    ds_read_b64_tr_b16 v[28:29], v9 offset:14336
    ds_read_b64_tr_b16 v[30:31], v9 offset:14848
    ds_read_b64_tr_b16 v[132:133], v9 offset:34816
    ds_read_b64_tr_b16 v[134:135], v9 offset:35328
    ds_read_b64_tr_b16 v[140:141], v9 offset:36864
    v_mfma_f32_32x32x16_bf16 v[48:63], v[20:23], v[104:107], v[48:63]
    s_waitcnt lgkmcnt(3)
    v_mfma_f32_32x32x16_bf16 v[32:47], v[24:27], v[108:111], v[32:47]
    ds_read_b64_tr_b16 v[16:17], v8 offset:32768
    ds_read_b64_tr_b16 v[18:19], v8 offset:33280
    ds_read_b64_tr_b16 v[20:21], v9 offset:32768
    ds_read_b64_tr_b16 v[22:23], v9 offset:33280
    ds_read_b64_tr_b16 v[142:143], v9 offset:37376
    ds_read_b64_tr_b16 v[148:149], v9 offset:38912
    ds_read_b64_tr_b16 v[150:151], v9 offset:39424
    s_waitcnt vmcnt(0)
    v_max3_u32 v11, v115, v119, v123
    v_max_u32 v11, v11, v127
    v_cmp_eq_u32 vcc, -1, v11
    v_mfma_f32_32x32x16_bf16 v[48:63], v[28:31], v[108:111], v[48:63]
    s_cbranch_vccnz H_RTS7
H_GOS7:
    s_waitcnt lgkmcnt(3)
    v_mfma_f32_32x32x16_bf16 v[32:47], v[16:19], v[112:115], v[32:47]
    v_mfma_f32_32x32x16_bf16 v[32:47], v[128:131], v[116:119], v[32:47]
    v_mfma_f32_32x32x16_bf16 v[32:47], v[136:139], v[120:123], v[32:47]
    v_mfma_f32_32x32x16_bf16 v[32:47], v[144:147], v[124:127], v[32:47]
    s_waitcnt lgkmcnt(0)
    v_mfma_f32_32x32x16_bf16 v[48:63], v[20:23], v[112:115], v[48:63]
    s_nop 6
    v_mfma_f32_32x32x16_bf16 v[48:63], v[132:135], v[116:119], v[48:63]
    s_nop 2
    v_mul_f32 v32, v32, v13
    v_mul_f32 v33, v33, v13
    v_mul_f32 v34, v34, v13
    v_mul_f32 v35, v35, v13
    v_mfma_f32_32x32x16_bf16 v[48:63], v[140:143], v[120:123], v[48:63]
    v_fma_f32 v32, v192, v13, v32
    v_fma_f32 v33, v193, v13, v33
    v_fma_f32 v34, v194, v13, v34
    v_fma_f32 v35, v195, v13, v35
    ds_write_b128 v4, v[32:35] offset:0
    v_mul_f32 v36, v36, v13
    v_mul_f32 v37, v37, v13
    v_mfma_f32_32x32x16_bf16 v[48:63], v[148:151], v[124:127], v[48:63]
    v_mul_f32 v38, v38, v13
    v_mul_f32 v39, v39, v13
    v_fma_f32 v36, v196, v13, v36
    v_fma_f32 v37, v197, v13, v37
    v_fma_f32 v38, v198, v13, v38
    v_fma_f32 v39, v199, v13, v39
    ds_write_b128 v4, v[36:39] offset:1024
    v_mul_f32 v40, v40, v13
    v_mul_f32 v41, v41, v13
    v_mul_f32 v42, v42, v13
    v_mul_f32 v43, v43, v13
    v_fma_f32 v40, v200, v13, v40
    v_fma_f32 v41, v201, v13, v41
    v_fma_f32 v42, v202, v13, v42
    v_fma_f32 v43, v203, v13, v43
    ds_write_b128 v4, v[40:43] offset:2048
    v_mul_f32 v44, v44, v13
    v_mul_f32 v45, v45, v13
    v_mul_f32 v46, v46, v13
    v_mul_f32 v47, v47, v13
    v_fma_f32 v44, v204, v13, v44
    v_fma_f32 v45, v205, v13, v45
    v_fma_f32 v46, v206, v13, v46
    v_fma_f32 v47, v207, v13, v47
    ds_write_b128 v4, v[44:47] offset:3072
    s_waitcnt lgkmcnt(0)
    s_barrier
    ds_read_b128 v[96:99], v5 offset:0
    ds_read_b128 v[100:103], v5 offset:1024
    ds_read_b128 v[104:107], v5 offset:2048
    ds_read_b128 v[108:111], v5 offset:3072
    v_pk_mul_f32 v[48:49], v[48:49], v[12:13] op_sel:[0,1]
    v_pk_mul_f32 v[50:51], v[50:51], v[12:13] op_sel:[0,1]
    v_pk_mul_f32 v[52:53], v[52:53], v[12:13] op_sel:[0,1]
    v_pk_mul_f32 v[54:55], v[54:55], v[12:13] op_sel:[0,1]
    v_pk_mul_f32 v[56:57], v[56:57], v[12:13] op_sel:[0,1]
    v_pk_mul_f32 v[58:59], v[58:59], v[12:13] op_sel:[0,1]
    v_pk_mul_f32 v[60:61], v[60:61], v[12:13] op_sel:[0,1]
    v_pk_mul_f32 v[62:63], v[62:63], v[12:13] op_sel:[0,1]
    v_pk_fma_f32 v[48:49], v[208:209], v[12:13], v[48:49] op_sel:[0,1,0]
    v_pk_fma_f32 v[50:51], v[210:211], v[12:13], v[50:51] op_sel:[0,1,0]
    v_pk_fma_f32 v[52:53], v[212:213], v[12:13], v[52:53] op_sel:[0,1,0]
    v_pk_fma_f32 v[54:55], v[214:215], v[12:13], v[54:55] op_sel:[0,1,0]
    v_pk_fma_f32 v[56:57], v[216:217], v[12:13], v[56:57] op_sel:[0,1,0]
    v_pk_fma_f32 v[58:59], v[218:219], v[12:13], v[58:59] op_sel:[0,1,0]
    v_pk_fma_f32 v[60:61], v[220:221], v[12:13], v[60:61] op_sel:[0,1,0]
    v_pk_fma_f32 v[62:63], v[222:223], v[12:13], v[62:63] op_sel:[0,1,0]
    s_branch H_FIN
H_RTF1:
    s_sub_u32 s101, s101, 1
    s_cbranch_scc1 K_END
    buffer_load_dwordx4 v[80:83], v1, s[28:31], s49 offen offset:0 sc1
    buffer_load_dwordx4 v[84:87], v1, s[28:31], s49 offen offset:1024 sc1
    buffer_load_dwordx4 v[88:91], v1, s[28:31], s49 offen offset:2048 sc1
    buffer_load_dwordx4 v[92:95], v1, s[28:31], s49 offen offset:3072 sc1
    buffer_load_dwordx4 v[96:99], v1, s[28:31], s50 offen offset:0 sc1
    buffer_load_dwordx4 v[100:103], v1, s[28:31], s50 offen offset:1024 sc1
    buffer_load_dwordx4 v[104:107], v1, s[28:31], s50 offen offset:2048 sc1
    buffer_load_dwordx4 v[108:111], v1, s[28:31], s50 offen offset:3072 sc1
    s_waitcnt vmcnt(4)
    v_max3_u32 v11, v83, v87, v91
    v_max_u32 v11, v11, v95
    v_cmp_eq_u32 vcc, -1, v11
    s_cbranch_vccnz H_RTF1
    s_branch H_GOF1
H_RTF2:
    s_sub_u32 s101, s101, 1
    s_cbranch_scc1 K_END
    buffer_load_dwordx4 v[96:99], v1, s[28:31], s50 offen offset:0 sc1
    buffer_load_dwordx4 v[100:103], v1, s[28:31], s50 offen offset:1024 sc1
    buffer_load_dwordx4 v[104:107], v1, s[28:31], s50 offen offset:2048 sc1
    buffer_load_dwordx4 v[108:111], v1, s[28:31], s50 offen offset:3072 sc1
    buffer_load_dwordx4 v[112:115], v1, s[28:31], s51 offen offset:0 sc1
    buffer_load_dwordx4 v[116:119], v1, s[28:31], s51 offen offset:1024 sc1
    buffer_load_dwordx4 v[120:123], v1, s[28:31], s51 offen offset:2048 sc1
    buffer_load_dwordx4 v[124:127], v1, s[28:31], s51 offen offset:3072 sc1
    s_waitcnt vmcnt(4)
    v_max3_u32 v11, v99, v103, v107
    v_max_u32 v11, v11, v111
    v_cmp_eq_u32 vcc, -1, v11
    s_cbranch_vccnz H_RTF2
    s_branch H_GOF2
H_RTF3:
    s_sub_u32 s101, s101, 1
    s_cbranch_scc1 K_END
    buffer_load_dwordx4 v[112:115], v1, s[28:31], s51 offen offset:0 sc1
    buffer_load_dwordx4 v[116:119], v1, s[28:31], s51 offen offset:1024 sc1
    buffer_load_dwordx4 v[120:123], v1, s[28:31], s51 offen offset:2048 sc1
    buffer_load_dwordx4 v[124:127], v1, s[28:31], s51 offen offset:3072 sc1
    buffer_load_dwordx4 v[128:131], v1, s[28:31], s52 offen offset:0 sc1
    buffer_load_dwordx4 v[132:135], v1, s[28:31], s52 offen offset:1024 sc1
    buffer_load_dwordx4 v[136:139], v1, s[28:31], s52 offen offset:2048 sc1
    buffer_load_dwordx4 v[140:143], v1, s[28:31], s52 offen offset:3072 sc1
    s_waitcnt vmcnt(4)
    v_max3_u32 v11, v115, v119, v123
    v_max_u32 v11, v11, v127
    v_cmp_eq_u32 vcc, -1, v11
    s_cbranch_vccnz H_RTF3
    s_branch H_GOF3
H_RTF4:
    s_sub_u32 s101, s101, 1
    s_cbranch_scc1 K_END
    buffer_load_dwordx4 v[128:131], v1, s[28:31], s52 offen offset:0 sc1
    buffer_load_dwordx4 v[132:135], v1, s[28:31], s52 offen offset:1024 sc1
    buffer_load_dwordx4 v[136:139], v1, s[28:31], s52 offen offset:2048 sc1
    buffer_load_dwordx4 v[140:143], v1, s[28:31], s52 offen offset:3072 sc1
    buffer_load_dwordx4 v[144:147], v1, s[28:31], s53 offen offset:0 sc1
    buffer_load_dwordx4 v[148:151], v1, s[28:31], s53 offen offset:1024 sc1
    buffer_load_dwordx4 v[152:155], v1, s[28:31], s53 offen offset:2048 sc1
    buffer_load_dwordx4 v[156:159], v1, s[28:31], s53 offen offset:3072 sc1
    s_waitcnt vmcnt(4)
    v_max3_u32 v11, v131, v135, v139
    v_max_u32 v11, v11, v143
    v_cmp_eq_u32 vcc, -1, v11
    s_cbranch_vccnz H_RTF4
    s_branch H_GOF4
H_RTF5:
    s_sub_u32 s101, s101, 1
    s_cbranch_scc1 K_END
    buffer_load_dwordx4 v[144:147], v1, s[28:31], s53 offen offset:0 sc1
    buffer_load_dwordx4 v[148:151], v1, s[28:31], s53 offen offset:1024 sc1
    buffer_load_dwordx4 v[152:155], v1, s[28:31], s53 offen offset:2048 sc1
    buffer_load_dwordx4 v[156:159], v1, s[28:31], s53 offen offset:3072 sc1
    buffer_load_dwordx4 v[160:163], v1, s[28:31], s54 offen offset:0 sc1
    buffer_load_dwordx4 v[164:167], v1, s[28:31], s54 offen offset:1024 sc1
    buffer_load_dwordx4 v[168:171], v1, s[28:31], s54 offen offset:2048 sc1
    buffer_load_dwordx4 v[172:175], v1, s[28:31], s54 offen offset:3072 sc1
    s_waitcnt vmcnt(4)
    v_max3_u32 v11, v147, v151, v155
    v_max_u32 v11, v11, v159
    v_cmp_eq_u32 vcc, -1, v11
    s_cbranch_vccnz H_RTF5
    s_branch H_GOF5
H_RTF6:
    s_sub_u32 s101, s101, 1
    s_cbranch_scc1 K_END
    buffer_load_dwordx4 v[160:163], v1, s[28:31], s54 offen offset:0 sc1
    buffer_load_dwordx4 v[164:167], v1, s[28:31], s54 offen offset:1024 sc1
    buffer_load_dwordx4 v[168:171], v1, s[28:31], s54 offen offset:2048 sc1
    buffer_load_dwordx4 v[172:175], v1, s[28:31], s54 offen offset:3072 sc1
    buffer_load_dwordx4 v[176:179], v1, s[28:31], s55 offen offset:0 sc1
    buffer_load_dwordx4 v[180:183], v1, s[28:31], s55 offen offset:1024 sc1
    buffer_load_dwordx4 v[184:187], v1, s[28:31], s55 offen offset:2048 sc1
    buffer_load_dwordx4 v[188:191], v1, s[28:31], s55 offen offset:3072 sc1
    s_waitcnt vmcnt(4)
    v_max3_u32 v11, v163, v167, v171
    v_max_u32 v11, v11, v175
    v_cmp_eq_u32 vcc, -1, v11
    s_cbranch_vccnz H_RTF6
    s_branch H_GOF6
H_RTF7:
    s_sub_u32 s101, s101, 1
    s_cbranch_scc1 K_END
    buffer_load_dwordx4 v[176:179], v1, s[28:31], s55 offen offset:0 sc1
    buffer_load_dwordx4 v[180:183], v1, s[28:31], s55 offen offset:1024 sc1
    buffer_load_dwordx4 v[184:187], v1, s[28:31], s55 offen offset:2048 sc1
    buffer_load_dwordx4 v[188:191], v1, s[28:31], s55 offen offset:3072 sc1
    s_waitcnt vmcnt(0)
    v_max3_u32 v11, v179, v183, v187
    v_max_u32 v11, v11, v191
    v_cmp_eq_u32 vcc, -1, v11
    s_cbranch_vccnz H_RTF7
    s_branch H_GOF7
H_RTS1:
    s_sub_u32 s101, s101, 1
    s_cbranch_scc1 K_END
    buffer_load_dwordx4 v[144:147], v1, s[28:31], s53 offen offset:0 sc1
    buffer_load_dwordx4 v[148:151], v1, s[28:31], s53 offen offset:1024 sc1
    buffer_load_dwordx4 v[152:155], v1, s[28:31], s53 offen offset:2048 sc1
    buffer_load_dwordx4 v[156:159], v1, s[28:31], s53 offen offset:3072 sc1
    buffer_load_dwordx4 v[160:163], v1, s[28:31], s54 offen offset:0 sc1
    buffer_load_dwordx4 v[164:167], v1, s[28:31], s54 offen offset:1024 sc1
    buffer_load_dwordx4 v[168:171], v1, s[28:31], s54 offen offset:2048 sc1
    buffer_load_dwordx4 v[172:175], v1, s[28:31], s54 offen offset:3072 sc1
    s_waitcnt vmcnt(4)
    v_max3_u32 v11, v147, v151, v155
    v_max_u32 v11, v11, v159
    v_cmp_eq_u32 vcc, -1, v11
    s_cbranch_vccnz H_RTS1
    s_branch H_GOS1
H_RTS2:
    s_sub_u32 s101, s101, 1
    s_cbranch_scc1 K_END
    buffer_load_dwordx4 v[160:163], v1, s[28:31], s54 offen offset:0 sc1
    buffer_load_dwordx4 v[164:167], v1, s[28:31], s54 offen offset:1024 sc1
    buffer_load_dwordx4 v[168:171], v1, s[28:31], s54 offen offset:2048 sc1
    buffer_load_dwordx4 v[172:175], v1, s[28:31], s54 offen offset:3072 sc1
    buffer_load_dwordx4 v[176:179], v1, s[28:31], s55 offen offset:0 sc1
    buffer_load_dwordx4 v[180:183], v1, s[28:31], s55 offen offset:1024 sc1
    buffer_load_dwordx4 v[184:187], v1, s[28:31], s55 offen offset:2048 sc1
    buffer_load_dwordx4 v[188:191], v1, s[28:31], s55 offen offset:3072 sc1
    s_waitcnt vmcnt(4)
    v_max3_u32 v11, v163, v167, v171
    v_max_u32 v11, v11, v175
    v_cmp_eq_u32 vcc, -1, v11
    s_cbranch_vccnz H_RTS2
    s_branch H_GOS2
H_RTS3:
    s_sub_u32 s101, s101, 1
    s_cbranch_scc1 K_END
    buffer_load_dwordx4 v[176:179], v1, s[28:31], s55 offen offset:0 sc1
    buffer_load_dwordx4 v[180:183], v1, s[28:31], s55 offen offset:1024 sc1
    buffer_load_dwordx4 v[184:187], v1, s[28:31], s55 offen offset:2048 sc1
    buffer_load_dwordx4 v[188:191], v1, s[28:31], s55 offen offset:3072 sc1
    buffer_load_dwordx4 v[64:67], v1, s[28:31], s48 offen offset:0 sc1
    buffer_load_dwordx4 v[68:71], v1, s[28:31], s48 offen offset:1024 sc1
    buffer_load_dwordx4 v[72:75], v1, s[28:31], s48 offen offset:2048 sc1
    buffer_load_dwordx4 v[76:79], v1, s[28:31], s48 offen offset:3072 sc1
    s_waitcnt vmcnt(4)
    v_max3_u32 v11, v179, v183, v187
    v_max_u32 v11, v11, v191
    v_cmp_eq_u32 vcc, -1, v11
    s_cbranch_vccnz H_RTS3
    s_branch H_GOS3
H_RTS4:
    s_sub_u32 s101, s101, 1
    s_cbranch_scc1 K_END
    buffer_load_dwordx4 v[64:67], v1, s[28:31], s48 offen offset:0 sc1
    buffer_load_dwordx4 v[68:71], v1, s[28:31], s48 offen offset:1024 sc1
    buffer_load_dwordx4 v[72:75], v1, s[28:31], s48 offen offset:2048 sc1
    buffer_load_dwordx4 v[76:79], v1, s[28:31], s48 offen offset:3072 sc1
    buffer_load_dwordx4 v[80:83], v1, s[28:31], s49 offen offset:0 sc1
    buffer_load_dwordx4 v[84:87], v1, s[28:31], s49 offen offset:1024 sc1
    buffer_load_dwordx4 v[88:91], v1, s[28:31], s49 offen offset:2048 sc1
    buffer_load_dwordx4 v[92:95], v1, s[28:31], s49 offen offset:3072 sc1
    s_waitcnt vmcnt(4)
    v_max3_u32 v11, v67, v71, v75
    v_max_u32 v11, v11, v79
    v_cmp_eq_u32 vcc, -1, v11
    s_cbranch_vccnz H_RTS4
    s_branch H_GOS4
H_RTS5:
    s_sub_u32 s101, s101, 1
    s_cbranch_scc1 K_END
    buffer_load_dwordx4 v[80:83], v1, s[28:31], s49 offen offset:0 sc1
    buffer_load_dwordx4 v[84:87], v1, s[28:31], s49 offen offset:1024 sc1
    buffer_load_dwordx4 v[88:91], v1, s[28:31], s49 offen offset:2048 sc1
    buffer_load_dwordx4 v[92:95], v1, s[28:31], s49 offen offset:3072 sc1
    buffer_load_dwordx4 v[96:99], v1, s[28:31], s50 offen offset:0 sc1
    buffer_load_dwordx4 v[100:103], v1, s[28:31], s50 offen offset:1024 sc1
    buffer_load_dwordx4 v[104:107], v1, s[28:31], s50 offen offset:2048 sc1
    buffer_load_dwordx4 v[108:111], v1, s[28:31], s50 offen offset:3072 sc1
    s_waitcnt vmcnt(4)
    v_max3_u32 v11, v83, v87, v91
    v_max_u32 v11, v11, v95
    v_cmp_eq_u32 vcc, -1, v11
    s_cbranch_vccnz H_RTS5
    s_branch H_GOS5
H_RTS6:
    s_sub_u32 s101, s101, 1
    s_cbranch_scc1 K_END
    buffer_load_dwordx4 v[96:99], v1, s[28:31], s50 offen offset:0 sc1
    buffer_load_dwordx4 v[100:103], v1, s[28:31], s50 offen offset:1024 sc1
    buffer_load_dwordx4 v[104:107], v1, s[28:31], s50 offen offset:2048 sc1
    buffer_load_dwordx4 v[108:111], v1, s[28:31], s50 offen offset:3072 sc1
    buffer_load_dwordx4 v[112:115], v1, s[28:31], s51 offen offset:0 sc1
    buffer_load_dwordx4 v[116:119], v1, s[28:31], s51 offen offset:1024 sc1
    buffer_load_dwordx4 v[120:123], v1, s[28:31], s51 offen offset:2048 sc1
    buffer_load_dwordx4 v[124:127], v1, s[28:31], s51 offen offset:3072 sc1
    s_waitcnt vmcnt(4)
    v_max3_u32 v11, v99, v103, v107
    v_max_u32 v11, v11, v111
    v_cmp_eq_u32 vcc, -1, v11
    s_cbranch_vccnz H_RTS6
    s_branch H_GOS6
H_RTS7:
    s_sub_u32 s101, s101, 1
    s_cbranch_scc1 K_END
    buffer_load_dwordx4 v[112:115], v1, s[28:31], s51 offen offset:0 sc1
    buffer_load_dwordx4 v[116:119], v1, s[28:31], s51 offen offset:1024 sc1
    buffer_load_dwordx4 v[120:123], v1, s[28:31], s51 offen offset:2048 sc1
    buffer_load_dwordx4 v[124:127], v1, s[28:31], s51 offen offset:3072 sc1
    s_waitcnt vmcnt(0)
    v_max3_u32 v11, v115, v119, v123
    v_max_u32 v11, v11, v127
    v_cmp_eq_u32 vcc, -1, v11
    s_cbranch_vccnz H_RTS7
    s_branch H_GOS7
.section .rodata,"a"
.p2align 6
.amdhsa_kernel gated_mix__softmax_full_mha__softmax_full_mha__prompt_kernel
  .amdhsa_next_free_vgpr 256
  .amdhsa_next_free_sgpr 102
  .amdhsa_accum_offset 256
  .amdhsa_group_segment_fixed_size 0
  .amdhsa_kernarg_size 80
  .amdhsa_user_sgpr_count 2
  .amdhsa_user_sgpr_kernarg_segment_ptr 1
  .amdhsa_system_sgpr_workgroup_id_x 1
.end_amdhsa_kernel
```
